```python
import torch

def _softmax(x, axis=-1):
    return torch.softmax(x, dim=axis)

def _gelu(x):
    return torch.nn.functional.gelu(x, approximate='tanh')

def _silu(x):
    return torch.nn.functional.silu(x)

def _sigmoid(x):
    return torch.sigmoid(x)

def _layernorm(x, axis=-1, eps=1e-05):
    m = x.mean(dim=axis, keepdim=True)
    v = x.var(dim=axis, keepdim=True, unbiased=False)
    return (x - m) / torch.sqrt(v + eps)

def _scatter_add(tgt, idx, src, axis=0):
    return tgt.clone().index_add_(axis, idx, src)

def _segment_sum(src, seg, n):
    out = torch.zeros((n,) + src.shape[1:], dtype=src.dtype)
    return out.index_add_(0, seg, src)

def _pad(x, pw):
    flat = tuple((v for pair in reversed(pw) for v in pair))
    return torch.nn.functional.pad(x, flat)
kernel_name = 'adaLN_cond__compressed_kv_cla__mixer_channel_mlp__decode'

def setup_inputs():

    _w = lambda a: (lambda t: t.to(torch.bfloat16) if t.is_floating_point() else t)(torch.as_tensor(a))

    def _A_setup():
        B, H, Sq, Sk, D, M = (2, 32, 1, 8192, 128, 512)
        Dc = 4 * D
        return {'x': _w((lambda *s: torch.randn(*s, dtype=torch.bfloat16) * 0.1)(B, Sq, M)), 'c_kv': _w((lambda *s: torch.randn(*s, dtype=torch.bfloat16) * 0.8)(B, Sk, Dc)), 'w_q': _w((lambda *s: torch.randn(*s, dtype=torch.bfloat16) * 0.8)(M, H, D) * M ** (-0.5)), 'w_uk': _w((lambda *s: torch.randn(*s, dtype=torch.bfloat16) * 0.8)(Dc, H, D) * Dc ** (-0.5)), 'w_uv': _w((lambda *s: torch.randn(*s, dtype=torch.bfloat16) * 0.8)(Dc, H, D) * Dc ** (-0.5)), 'w_o': _w((lambda *s: torch.randn(*s, dtype=torch.bfloat16) * 0.8)(H, D, M) * (H * D) ** (-0.5))}
    _A_in = _A_setup()

    def _B_setup():
        B, S, D, F = (2, 1, 512, 1792)
        return {'x': _w((lambda *s: torch.randn(*s, dtype=torch.bfloat16) * 0.1)(B, S, D)), 'w1': _w((lambda *s: torch.randn(*s, dtype=torch.bfloat16) * 3.2)(D, F) * D ** (-0.5)), 'b1': _w((lambda *s: torch.randn(*s, dtype=torch.bfloat16) * 3.2)(F)), 'w2': _w((lambda *s: torch.randn(*s, dtype=torch.bfloat16) * 0.8)(F, D) * F ** (-0.5)), 'b2': _w((lambda *s: torch.randn(*s, dtype=torch.bfloat16) * 1.6)(D))}
    _B_in = _B_setup()
    return {'A_x': _A_in['x'], 'A_c_kv': _A_in['c_kv'], 'A_w_q': _A_in['w_q'], 'A_w_uk': _A_in['w_uk'], 'A_w_uv': _A_in['w_uv'], 'A_w_o': _A_in['w_o'], 'B_x': _B_in['x'], 'B_w1': _B_in['w1'], 'B_b1': _B_in['b1'], 'B_w2': _B_in['w2'], 'B_b2': _B_in['b2'], 'c': _w((lambda *s: torch.randn(*s, dtype=torch.bfloat16) * 0.8)(2, 512) * 8.0), 'w_mod': _w((lambda *s: torch.randn(*s, dtype=torch.bfloat16) * 0.8)(512, 6 * 512) * 512 ** (-0.5) * 8.0)}

def reference(A_x, A_c_kv, A_w_q, A_w_uk, A_w_uv, A_w_o, B_x, B_w1, B_b1, B_w2, B_b2, c, w_mod):

    def _A_ref(x, c_kv, w_q, w_uk, w_uv, w_o):
        B, Sq, M = (x.shape[0], x.shape[1], x.shape[2])
        Sk = c_kv.shape[1]
        H, D = (w_q.shape[1], w_q.shape[2])
        q = torch.einsum('bqm,mhd->bhqd', x, w_q)
        k = torch.einsum('bkc,chd->bhkd', c_kv, w_uk)
        v = torch.einsum('bkc,chd->bhkd', c_kv, w_uv)
        scores = torch.einsum('bhqd,bhkd->bhqk', q, k) * D ** (-0.5)
        off = Sk - Sq
        qi = torch.arange(Sq)[:, None]
        kj = torch.arange(Sk)[None, :]
        cmask = kj <= qi + off
        scores = torch.where(cmask[None, None], scores, -1000000000.0)
        p = _softmax(scores, axis=-1)
        ctx = torch.einsum('bhqk,bhkd->bhqd', p, v)
        return torch.einsum('bhqd,hdm->bqm', ctx, w_o)

    def _B_ref(x, w1, b1, w2, b2):
        y = _layernorm(x, axis=-1)
        h = _gelu(torch.einsum('bsd,df->bsf', y, w1) + b1)
        return torch.einsum('bsf,fd->bsd', h, w2) + b2
    x = A_x
    mod = (_silu(c) @ w_mod).reshape(c.shape[0], 6, 1, -1)
    sa, ca, ga, sb, cb, gb = (mod[:, 0].clone(), mod[:, 1].clone(), mod[:, 2].clone(), mod[:, 3].clone(), mod[:, 4].clone(), mod[:, 5].clone())
    h = _layernorm(x, axis=-1) * (1 + ca) + sa
    x = x + ga * _A_ref(h, A_c_kv, A_w_q, A_w_uk, A_w_uv, A_w_o)
    h = _layernorm(x, axis=-1) * (1 + cb) + sb
    x = x + gb * _B_ref(h, B_w1, B_b1, B_w2, B_b2)
    return x
```

```asm
; @launch grid=(248,1,1) block=(256,1,1) lds=160768
.amdgcn_target "amdgcn-amd-amdhsa--gfx950"
.text
.globl adaLN_cond__compressed_kv_cla__mixer_channel_mlp__decode_kernel
.p2align 8
.type adaLN_cond__compressed_kv_cla__mixer_channel_mlp__decode_kernel,@function
adaLN_cond__compressed_kv_cla__mixer_channel_mlp__decode_kernel:
    s_load_dwordx16 s[4:19], s[0:1], 0
    s_load_dwordx16 s[20:35], s[0:1], 64
    s_cmp_ge_u32 s2, 248
    s_cbranch_scc1 END
    v_lshrrev_b32 v1, 6, v0
    v_and_b32 v0, 63, v0
    s_and_b32 s36, s2, 7
    s_lshr_b32 s37, s2, 3
    v_readfirstlane_b32 s38, v1
    v_and_b32 v2, 15, v0
    v_lshrrev_b32 v3, 4, v0
    v_lshlrev_b32 v4, 4, v0
    v_lshlrev_b32 v1, 2, v0
    v_lshrrev_b32 v6, 3, v2
    v_and_b32 v7, 7, v2
    v_mov_b32 v28, -1
    v_mov_b32 v29, -1
    s_mov_b32 s66, 0x05040100
    s_mov_b32 s67, 0x07060302
    s_mov_b32 s65, 0x3b000000
    s_cmp_ge_u32 s37, 15
    s_cbranch_scc1 ROLE_A
    s_cmp_ge_u32 s37, 7
    s_cbranch_scc1 ROLE_E
    s_mov_b32 s58, s36
    s_mov_b32 s59, s37
    s_lshr_b32 s40, s36, 1
    s_cmp_eq_u32 s40, 2
    s_cbranch_scc1 ROLE_QI
    s_cmp_lt_u32 s37, 4
    s_cbranch_scc1 ROLE_P
    s_cmp_ge_u32 s2, 44
    s_cbranch_scc1 ROLE_QI
    s_cmp_eq_u32 s40, 3
    s_cbranch_scc1 ROLE_QI
    s_add_u32 s58, s40, 4
    s_and_b32 s59, s36, 1
    s_lshl1_add_u32 s59, s59, s37
    s_sub_u32 s59, s59, 4
ROLE_P:
    s_lshl_b32 s40, s59, 2
    s_add_u32 s40, s40, s38
    s_mul_i32 s41, s40, 196608
    s_xor_b32 s39, s58, 3
    s_lshl_b32 s42, s39, 7
    s_add_u32 s41, s41, s42
    s_add_u32 s41, s41, 3072
    v_mul_u32_u24 v5, 49152, v3
    v_lshl_add_u32 v5, v6, 10, v5
    v_lshl_add_u32 v5, v7, 4, v5
    s_lshl_b32 s43, s40, 6
    v_lshl_add_u32 v8, v6, 10, s43
    v_lshl_add_u32 v8, v3, 4, v8
    v_lshlrev_b32 v9, 5, v0
    v_lshrrev_b32 v10, 1, v3
    v_lshl_add_u32 v10, v10, 10, s42
    v_lshl_add_u32 v10, v7, 4, v10
    v_and_b32 v11, 1, v3
    v_lshl_add_u32 v10, v11, 3, v10
    s_waitcnt lgkmcnt(0)
    s_add_u32 s44, s28, s41
    s_addc_u32 s45, s29, 0
    global_load_dwordx4 v[12:15], v8, s[26:27]
    global_load_dwordx4 v[32:35], v5, s[44:45] offset:-3072
    global_load_dwordx4 v[36:39], v5, s[44:45] offset:3072
    global_load_dwordx4 v[16:19], v9, s[4:5]
    global_load_dwordx4 v[20:23], v9, s[4:5] offset:16
    global_load_dwordx2 v[24:25], v10, s[4:5]
    v_add_u32 v5, 12288, v5
    global_load_dwordx4 v[40:43], v5, s[44:45] offset:-3072
    global_load_dwordx4 v[44:47], v5, s[44:45] offset:3072
    v_add_u32 v5, 12288, v5
    global_load_dwordx4 v[48:51], v5, s[44:45] offset:-3072
    global_load_dwordx4 v[52:55], v5, s[44:45] offset:3072
    v_add_u32 v5, 12288, v5
    global_load_dwordx4 v[56:59], v5, s[44:45] offset:-3072
    global_load_dwordx4 v[60:63], v5, s[44:45] offset:3072
    s_load_dword s63, s[34:35], 261120
    s_add_u32 s62, s58, s59
    s_and_b32 s62, s62, 7
    s_mul_i32 s53, s36, 7
    s_add_u32 s53, s53, s37
    s_and_b32 s54, s53, 1
    s_lshr_b32 s55, s53, 1
    s_mul_i32 s57, s54, 28
    s_add_u32 s41, s57, s55
    s_lshl_b32 s41, s41, 11
    s_lshl_b32 s49, s38, 9
    s_add_u32 s41, s41, s49
    s_add_u32 s41, s41, 393216
    v_lshl_add_u32 v8, v0, 3, s41
    global_store_dwordx2 v8, v[28:29], s[34:35] sc1
    s_lshl_b32 s41, s59, 14
    s_lshl_b32 s42, s62, 10
    s_add_u32 s41, s41, s42
    s_lshr_b32 s42, s38, 1
    s_lshl_b32 s42, s42, 13
    s_add_u32 s41, s41, s42
    s_and_b32 s42, s38, 1
    s_lshl_b32 s42, s42, 9
    s_add_u32 s41, s41, s42
    s_add_u32 s41, s41, 327680
    v_lshl_add_u32 v8, v0, 3, s41
    global_store_dwordx2 v8, v[28:29], s[34:35] sc1
    v_and_b32 v8, 1, v2
    v_lshlrev_b32 v8, 4, v8
    v_mov_b32 v99, 65535
    v_lshlrev_b32 v99, v8, v99
    v_bfe_u32 v8, v2, 1, 2
    v_cmp_eq_u32 vcc, 0, v8
    s_nop 1
    v_cndmask_b32 v96, 0, v99, vcc
    v_cmp_eq_u32 vcc, 1, v8
    s_nop 1
    v_cndmask_b32 v97, 0, v99, vcc
    v_cmp_eq_u32 vcc, 2, v8
    s_nop 1
    v_cndmask_b32 v98, 0, v99, vcc
    v_cmp_eq_u32 vcc, 3, v8
    s_nop 1
    v_cndmask_b32 v99, 0, v99, vcc
    s_waitcnt vmcnt(13)
    v_lshlrev_b32 v100, 16, v12
    v_and_b32 v101, 0xffff0000, v12
    v_lshlrev_b32 v102, 16, v13
    v_and_b32 v103, 0xffff0000, v13
    v_lshlrev_b32 v104, 16, v14
    v_and_b32 v105, 0xffff0000, v14
    v_lshlrev_b32 v106, 16, v15
    v_and_b32 v107, 0xffff0000, v15
    v_mul_f32 v108, 0xbfb8aa3b, v100
    v_mul_f32 v109, 0xbfb8aa3b, v101
    v_mul_f32 v110, 0xbfb8aa3b, v102
    v_mul_f32 v111, 0xbfb8aa3b, v103
    v_mul_f32 v112, 0xbfb8aa3b, v104
    v_mul_f32 v113, 0xbfb8aa3b, v105
    v_mul_f32 v114, 0xbfb8aa3b, v106
    v_mul_f32 v115, 0xbfb8aa3b, v107
    v_exp_f32 v108, v108
    v_exp_f32 v109, v109
    v_exp_f32 v110, v110
    v_exp_f32 v111, v111
    v_exp_f32 v112, v112
    v_exp_f32 v113, v113
    v_exp_f32 v114, v114
    v_exp_f32 v115, v115
    v_add_f32 v108, 1.0, v108
    v_add_f32 v109, 1.0, v109
    v_add_f32 v110, 1.0, v110
    v_add_f32 v111, 1.0, v111
    v_add_f32 v112, 1.0, v112
    v_add_f32 v113, 1.0, v113
    v_add_f32 v114, 1.0, v114
    v_add_f32 v115, 1.0, v115
    v_rcp_f32 v108, v108
    v_rcp_f32 v109, v109
    v_rcp_f32 v110, v110
    v_rcp_f32 v111, v111
    v_rcp_f32 v112, v112
    v_rcp_f32 v113, v113
    v_rcp_f32 v114, v114
    v_rcp_f32 v115, v115
    v_mul_f32 v100, v100, v108
    v_mul_f32 v101, v101, v109
    v_mul_f32 v102, v102, v110
    v_mul_f32 v103, v103, v111
    v_mul_f32 v104, v104, v112
    v_mul_f32 v105, v105, v113
    v_mul_f32 v106, v106, v114
    v_mul_f32 v107, v107, v115
    v_cvt_pk_bf16_f32 v100, v100, v100
    v_cvt_pk_bf16_f32 v101, v101, v101
    v_cvt_pk_bf16_f32 v102, v102, v102
    v_cvt_pk_bf16_f32 v103, v103, v103
    v_cvt_pk_bf16_f32 v104, v104, v104
    v_cvt_pk_bf16_f32 v105, v105, v105
    v_cvt_pk_bf16_f32 v106, v106, v106
    v_cvt_pk_bf16_f32 v107, v107, v107
    v_and_b32 v64, v96, v100
    v_and_b32 v65, v97, v100
    v_and_b32 v66, v98, v100
    v_and_b32 v67, v99, v100
    v_and_b32 v68, v96, v101
    v_and_b32 v69, v97, v101
    v_and_b32 v70, v98, v101
    v_and_b32 v71, v99, v101
    v_and_b32 v72, v96, v102
    v_and_b32 v73, v97, v102
    v_and_b32 v74, v98, v102
    v_and_b32 v75, v99, v102
    v_and_b32 v76, v96, v103
    v_and_b32 v77, v97, v103
    v_and_b32 v78, v98, v103
    v_and_b32 v79, v99, v103
    v_and_b32 v80, v96, v104
    v_and_b32 v81, v97, v104
    v_and_b32 v82, v98, v104
    v_and_b32 v83, v99, v104
    v_and_b32 v84, v96, v105
    v_and_b32 v85, v97, v105
    v_and_b32 v86, v98, v105
    v_and_b32 v87, v99, v105
    v_and_b32 v88, v96, v106
    v_and_b32 v89, v97, v106
    v_and_b32 v90, v98, v106
    v_and_b32 v91, v99, v106
    v_and_b32 v92, v96, v107
    v_and_b32 v93, v97, v107
    v_and_b32 v94, v98, v107
    v_and_b32 v95, v99, v107
    v_mov_b32 v8, 0
    v_mov_b32 v9, 0
    v_mov_b32 v10, 0x3f803f80
    s_waitcnt vmcnt(10)
    v_dot2c_f32_bf16 v8, v16, v10
    v_dot2c_f32_bf16 v9, v16, v16
    v_dot2c_f32_bf16 v8, v17, v10
    v_dot2c_f32_bf16 v9, v17, v17
    v_dot2c_f32_bf16 v8, v18, v10
    v_dot2c_f32_bf16 v9, v18, v18
    v_dot2c_f32_bf16 v8, v19, v10
    v_dot2c_f32_bf16 v9, v19, v19
    s_waitcnt vmcnt(9)
    v_dot2c_f32_bf16 v8, v20, v10
    v_dot2c_f32_bf16 v9, v20, v20
    v_dot2c_f32_bf16 v8, v21, v10
    v_dot2c_f32_bf16 v9, v21, v21
    v_dot2c_f32_bf16 v8, v22, v10
    v_dot2c_f32_bf16 v9, v22, v22
    v_dot2c_f32_bf16 v8, v23, v10
    v_dot2c_f32_bf16 v9, v23, v23
    s_nop 1
    v_add_f32_dpp v8, v8, v8 row_ror:8 row_mask:0xf bank_mask:0xf
    v_add_f32_dpp v9, v9, v9 row_ror:8 row_mask:0xf bank_mask:0xf
    s_nop 0
    v_add_f32_dpp v8, v8, v8 row_ror:4 row_mask:0xf bank_mask:0xf
    v_add_f32_dpp v9, v9, v9 row_ror:4 row_mask:0xf bank_mask:0xf
    s_nop 0
    v_add_f32_dpp v8, v8, v8 row_ror:2 row_mask:0xf bank_mask:0xf
    v_add_f32_dpp v9, v9, v9 row_ror:2 row_mask:0xf bank_mask:0xf
    s_nop 0
    v_add_f32_dpp v8, v8, v8 row_ror:1 row_mask:0xf bank_mask:0xf
    v_add_f32_dpp v9, v9, v9 row_ror:1 row_mask:0xf bank_mask:0xf
    v_mov_b32 v10, v8
    v_mov_b32 v11, v9
    s_nop 0
    v_permlane16_swap_b32 v8, v10
    v_permlane16_swap_b32 v9, v11
    v_add_f32 v8, v8, v10
    v_add_f32 v9, v9, v11
    v_mul_f32 v8, 0x3b000000, v8
    v_mul_f32 v10, v8, v8
    v_fma_f32 v9, v9, s65, -v10
    v_max_f32 v9, 0, v9
    v_add_f32 v9, 0x3727c5ac, v9
    v_rsq_f32 v9, v9
    s_waitcnt vmcnt(8)
    v_lshlrev_b32 v16, 16, v24
    v_and_b32 v17, 0xffff0000, v24
    v_lshlrev_b32 v18, 16, v25
    v_and_b32 v19, 0xffff0000, v25
    v_cmp_le_u32 vcc, 8, v2
    s_cmp_eq_u32 s40, 0
    s_cselect_b32 s49, 1.0, 0
    v_mov_b32 v20, s49
    v_sub_f32 v16, v16, v8
    v_mul_f32 v16, v16, v9
    v_cndmask_b32 v16, 1.0, v16, vcc
    v_cndmask_b32 v12, 0, v20, vcc
    v_sub_f32 v17, v17, v8
    v_mul_f32 v17, v17, v9
    v_cndmask_b32 v17, 1.0, v17, vcc
    v_cndmask_b32 v13, 0, v20, vcc
    v_sub_f32 v18, v18, v8
    v_mul_f32 v18, v18, v9
    v_cndmask_b32 v18, 1.0, v18, vcc
    v_cndmask_b32 v14, 0, v20, vcc
    v_sub_f32 v19, v19, v8
    v_mul_f32 v19, v19, v9
    v_cndmask_b32 v19, 1.0, v19, vcc
    v_cndmask_b32 v15, 0, v20, vcc
    s_lshl_b32 s49, s38, 10
    s_add_u32 s49, s49, 152576
    v_add_u32 v21, s49, v4
    v_add_u32 v22, 152576, v4
    s_lshl_b32 s43, s39, 2
    s_add_u32 s43, s43, s59
    s_lshl_b32 s43, s43, 9
    v_lshrrev_b32 v23, 1, v3
    v_lshl_add_u32 v23, v23, 2, s59
    v_xor_b32 v23, v23, v7
    v_lshl_add_u32 v30, v3, 7, s43
    v_lshl_add_u32 v30, v23, 4, v30
    v_and_b32 v23, 16, v0
    v_cmp_ne_u32 s[60:61], 0, v23
    s_waitcnt lgkmcnt(0)
    s_mul_i32 s63, s63, 0x9e3779b1
    s_add_u32 s63, s63, 0x7f4a7c15
    v_mov_b32 v31, s63
    v_mfma_f32_16x16x32_bf16 v[12:15], v[64:67], v[32:35], v[12:15]
    v_mfma_f32_16x16x32_bf16 v[12:15], v[68:71], v[36:39], v[12:15]
    s_waitcnt vmcnt(7)
    v_mfma_f32_16x16x32_bf16 v[12:15], v[72:75], v[40:43], v[12:15]
    s_waitcnt vmcnt(6)
    v_mfma_f32_16x16x32_bf16 v[12:15], v[76:79], v[44:47], v[12:15]
    s_waitcnt vmcnt(5)
    v_mfma_f32_16x16x32_bf16 v[12:15], v[80:83], v[48:51], v[12:15]
    s_waitcnt vmcnt(4)
    v_mfma_f32_16x16x32_bf16 v[12:15], v[84:87], v[52:55], v[12:15]
    s_waitcnt vmcnt(3)
    v_mfma_f32_16x16x32_bf16 v[12:15], v[88:91], v[56:59], v[12:15]
    s_waitcnt vmcnt(2)
    v_mfma_f32_16x16x32_bf16 v[12:15], v[92:95], v[60:63], v[12:15]
    s_nop 7
    v_pk_mul_f32 v[12:13], v[12:13], v[16:17]
    v_pk_mul_f32 v[14:15], v[14:15], v[18:19]
    ds_write_b128 v21, v[12:15]
    s_waitcnt lgkmcnt(0)
    s_barrier
    s_cmp_lg_u32 s38, 0
    s_cbranch_scc1 P1_1
    ds_read_b128 v[36:39], v22 offset:1024
    ds_read_b128 v[40:43], v22 offset:2048
    ds_read_b128 v[44:47], v22 offset:3072
    s_waitcnt lgkmcnt(2)
    v_pk_add_f32 v[12:13], v[12:13], v[36:37]
    v_pk_add_f32 v[14:15], v[14:15], v[38:39]
    s_waitcnt lgkmcnt(0)
    v_pk_add_f32 v[40:41], v[40:41], v[44:45]
    v_pk_add_f32 v[42:43], v[42:43], v[46:47]
    v_pk_add_f32 v[12:13], v[12:13], v[40:41]
    v_pk_add_f32 v[14:15], v[14:15], v[42:43]
    s_nop 0
    v_add_f32_dpp v12, v12, v12 row_ror:8 row_mask:0xf bank_mask:0xf
    v_add_f32_dpp v13, v13, v13 row_ror:8 row_mask:0xf bank_mask:0xf
    v_add_f32_dpp v14, v14, v14 row_ror:8 row_mask:0xf bank_mask:0xf
    v_add_f32_dpp v15, v15, v15 row_ror:8 row_mask:0xf bank_mask:0xf
    v_cvt_pk_bf16_f32 v12, v12, v13
    v_cvt_pk_bf16_f32 v13, v14, v15
    v_cndmask_b32 v16, v31, v12, s[60:61]
    v_cndmask_b32 v17, v31, v13, s[60:61]
    v_cndmask_b32 v18, v12, v31, s[60:61]
    v_cndmask_b32 v19, v13, v31, s[60:61]
    s_mov_b32 exec_lo, 0x00ff00ff
    s_mov_b32 exec_hi, 0x00ff00ff
    global_store_dwordx4 v30, v[16:19], s[34:35] sc1
    s_mov_b64 exec, -1
P1_1:
    s_waitcnt vmcnt(0)
    s_barrier
    s_lshl_b32 s68, s2, 7
    s_add_u32 s68, s68, 229376
    v_add_u32 v8, s68, v1
    v_mov_b32 v9, s63
    s_cmp_eq_u32 s38, 0
    s_cselect_b32 exec_lo, -1, 0
    s_mov_b32 exec_hi, 0
    global_store_dword v8, v9, s[34:35] sc1
    s_mov_b64 exec, -1
    s_mov_b32 s41, s37
    s_lshr_b32 s42, s36, 1
    s_mov_b32 s41, s37
    s_mov_b32 s43, 6
    s_cmp_eq_u32 s42, 2
    s_cselect_b32 s46, 4, 4
    s_cmp_lg_u32 s42, 3
    s_cbranch_scc1 KH_2s
    s_mov_b32 s46, 4
    s_and_b32 s41, s37, 2
    s_add_u32 s41, s41, s37
    s_add_u32 s41, s41, 2
    s_mov_b32 s43, 8
KH_2s:
    s_lshr_b32 s47, s46, 1
    s_sub_u32 s47, 8, s47
    s_lshl_b32 s46, s46, 3
    s_lshl_b32 s48, s38, 15
    s_add_u32 m0, s48, 16384
    s_lshl_b32 s48, s38, 12
    v_add_u32 v5, s48, v4
KH_2:
    s_cmp_ge_u32 s41, s46
    s_cbranch_scc1 KD_3
    s_lshr_b32 s48, s41, 4
    s_add_u32 s48, s48, s47
    s_and_b32 s49, s41, 8
    s_add_u32 s48, s48, s49
    s_and_b32 s49, s48, 4
    s_lshl_b32 s48, s48, 19
    s_lshl_b32 s49, s49, 16
    s_or_b32 s48, s48, s49
    s_and_b32 s49, s41, 4
    s_lshl_b32 s49, s49, 21
    s_or_b32 s48, s48, s49
    s_and_b32 s49, s41, 3
    s_lshl3_add_u32 s49, s49, s36
    s_lshl_b32 s49, s49, 14
    s_xor_b32 s48, s48, s49
    v_add_u32 v8, s48, v5
    global_load_lds_dwordx4 v8, s[6:7] offset:0
    global_load_lds_dwordx4 v8, s[6:7] offset:1024
    global_load_lds_dwordx4 v8, s[6:7] offset:2048
    global_load_lds_dwordx4 v8, s[6:7] offset:3072
    s_add_u32 s41, s41, s43
    s_branch KH_2
KD_3:
    s_lshl_b32 s49, s2, 7
    s_add_u32 s49, s49, 72704
    v_mov_b32 v30, s49
    s_mov_b32 s69, 65536
FL_4:
    global_load_dword v31, v30, s[34:35] sc1
    s_waitcnt vmcnt(0)
    v_cmp_ne_u32 vcc, s63, v31
    s_cbranch_vccz FD_5
    s_sub_u32 s69, s69, 1
    s_cbranch_scc0 FL_4
FD_5:
    s_mul_i32 s41, s40, 196608
    s_lshl_b32 s42, s62, 9
    s_add_u32 s41, s41, s42
    s_add_u32 s41, s41, 5120
    s_add_u32 s44, s28, s41
    s_addc_u32 s45, s29, 0
    v_mul_u32_u24 v5, 49152, v3
    v_lshl_add_u32 v5, v2, 4, v5
    global_load_dwordx4 v[128:131], v5, s[44:45] offset:-3072
    global_load_dwordx4 v[160:163], v5, s[44:45] offset:-2816
    global_load_dwordx4 v[132:135], v5, s[44:45] offset:3072
    global_load_dwordx4 v[164:167], v5, s[44:45] offset:3328
    v_add_u32 v5, 12288, v5
    global_load_dwordx4 v[136:139], v5, s[44:45] offset:-3072
    global_load_dwordx4 v[168:171], v5, s[44:45] offset:-2816
    global_load_dwordx4 v[140:143], v5, s[44:45] offset:3072
    global_load_dwordx4 v[172:175], v5, s[44:45] offset:3328
    v_add_u32 v5, 12288, v5
    global_load_dwordx4 v[144:147], v5, s[44:45] offset:-3072
    global_load_dwordx4 v[176:179], v5, s[44:45] offset:-2816
    global_load_dwordx4 v[148:151], v5, s[44:45] offset:3072
    global_load_dwordx4 v[180:183], v5, s[44:45] offset:3328
    v_add_u32 v5, 12288, v5
    global_load_dwordx4 v[152:155], v5, s[44:45] offset:-3072
    global_load_dwordx4 v[184:187], v5, s[44:45] offset:-2816
    global_load_dwordx4 v[156:159], v5, s[44:45] offset:3072
    global_load_dwordx4 v[188:191], v5, s[44:45] offset:3328
    s_mul_i32 s41, s38, 458752
    s_lshl_b32 s42, s55, 7
    s_add_u32 s41, s41, s42
    s_add_u32 s46, s18, s41
    s_addc_u32 s47, s19, 0
    v_lshrrev_b32 v26, 3, v0
    v_mul_u32_u24 v26, 3584, v26
    v_lshl_add_u32 v26, v7, 4, v26
    s_lshl_b32 s48, s38, 15
    s_add_u32 m0, s48, 0
    s_nop 0
    global_load_lds_dwordx4 v26, s[46:47]
    v_add_u32 v26, 28672, v26
    s_add_u32 m0, s48, 1024
    s_nop 0
    global_load_lds_dwordx4 v26, s[46:47]
    v_add_u32 v26, 28672, v26
    s_add_u32 m0, s48, 2048
    s_nop 0
    global_load_lds_dwordx4 v26, s[46:47]
    v_add_u32 v26, 28672, v26
    s_add_u32 m0, s48, 3072
    s_nop 0
    global_load_lds_dwordx4 v26, s[46:47]
    v_add_u32 v26, 28672, v26
    s_add_u32 m0, s48, 4096
    s_nop 0
    global_load_lds_dwordx4 v26, s[46:47]
    v_add_u32 v26, 28672, v26
    s_add_u32 m0, s48, 5120
    s_nop 0
    global_load_lds_dwordx4 v26, s[46:47]
    v_add_u32 v26, 28672, v26
    s_add_u32 m0, s48, 6144
    s_nop 0
    global_load_lds_dwordx4 v26, s[46:47]
    v_add_u32 v26, 28672, v26
    s_add_u32 m0, s48, 7168
    s_nop 0
    global_load_lds_dwordx4 v26, s[46:47]
    v_add_u32 v26, 28672, v26
    s_add_u32 m0, s48, 8192
    s_nop 0
    global_load_lds_dwordx4 v26, s[46:47]
    v_add_u32 v26, 28672, v26
    s_add_u32 m0, s48, 9216
    s_nop 0
    global_load_lds_dwordx4 v26, s[46:47]
    v_add_u32 v26, 28672, v26
    s_add_u32 m0, s48, 10240
    s_nop 0
    global_load_lds_dwordx4 v26, s[46:47]
    v_add_u32 v26, 28672, v26
    s_add_u32 m0, s48, 11264
    s_nop 0
    global_load_lds_dwordx4 v26, s[46:47]
    v_add_u32 v26, 28672, v26
    s_add_u32 m0, s48, 12288
    s_nop 0
    global_load_lds_dwordx4 v26, s[46:47]
    v_add_u32 v26, 28672, v26
    s_add_u32 m0, s48, 13312
    s_nop 0
    global_load_lds_dwordx4 v26, s[46:47]
    v_add_u32 v26, 28672, v26
    s_add_u32 m0, s48, 14336
    s_nop 0
    global_load_lds_dwordx4 v26, s[46:47]
    v_add_u32 v26, 28672, v26
    s_add_u32 m0, s48, 15360
    s_nop 0
    global_load_lds_dwordx4 v26, s[46:47]
    v_add_u32 v26, 28672, v26
    s_waitcnt vmcnt(31)
    v_mfma_f32_16x16x32_bf16 v[12:15], v[64:67], v[128:131], 0
    s_waitcnt vmcnt(30)
    v_mfma_f32_16x16x32_bf16 v[16:19], v[64:67], v[160:163], 0
    s_waitcnt vmcnt(29)
    v_mfma_f32_16x16x32_bf16 v[12:15], v[68:71], v[132:135], v[12:15]
    s_waitcnt vmcnt(28)
    v_mfma_f32_16x16x32_bf16 v[16:19], v[68:71], v[164:167], v[16:19]
    s_waitcnt vmcnt(27)
    v_mfma_f32_16x16x32_bf16 v[12:15], v[72:75], v[136:139], v[12:15]
    s_waitcnt vmcnt(26)
    v_mfma_f32_16x16x32_bf16 v[16:19], v[72:75], v[168:171], v[16:19]
    s_waitcnt vmcnt(25)
    v_mfma_f32_16x16x32_bf16 v[12:15], v[76:79], v[140:143], v[12:15]
    s_waitcnt vmcnt(24)
    v_mfma_f32_16x16x32_bf16 v[16:19], v[76:79], v[172:175], v[16:19]
    s_waitcnt vmcnt(23)
    v_mfma_f32_16x16x32_bf16 v[12:15], v[80:83], v[144:147], v[12:15]
    s_waitcnt vmcnt(22)
    v_mfma_f32_16x16x32_bf16 v[16:19], v[80:83], v[176:179], v[16:19]
    s_waitcnt vmcnt(21)
    v_mfma_f32_16x16x32_bf16 v[12:15], v[84:87], v[148:151], v[12:15]
    s_waitcnt vmcnt(20)
    v_mfma_f32_16x16x32_bf16 v[16:19], v[84:87], v[180:183], v[16:19]
    s_waitcnt vmcnt(19)
    v_mfma_f32_16x16x32_bf16 v[12:15], v[88:91], v[152:155], v[12:15]
    s_waitcnt vmcnt(18)
    v_mfma_f32_16x16x32_bf16 v[16:19], v[88:91], v[184:187], v[16:19]
    s_waitcnt vmcnt(17)
    v_mfma_f32_16x16x32_bf16 v[12:15], v[92:95], v[156:159], v[12:15]
    s_waitcnt vmcnt(16)
    v_mfma_f32_16x16x32_bf16 v[16:19], v[92:95], v[188:191], v[16:19]
    s_nop 5
    ds_write_b128 v21, v[12:15]
    s_nop 0
    ds_write_b128 v21, v[16:19] offset:4096
    v_bfe_u32 v22, v0, 1, 4
    v_and_b32 v23, 1, v0
    v_lshl_add_u32 v22, v23, 4, v22
    v_and_b32 v23, 32, v0
    v_add_u32 v22, v22, v23
    s_lshl_b32 s49, s38, 12
    s_add_u32 s49, s49, 152576
    v_lshl_add_u32 v22, v22, 4, s49
    s_lshl_b32 s41, s59, 14
    s_lshl_b32 s42, s62, 10
    s_add_u32 s41, s41, s42
    s_lshl_b32 s42, s38, 9
    s_add_u32 s41, s41, s42
    s_add_u32 s41, s41, 327680
    v_lshl_add_u32 v24, v23, 8, s41
    v_and_b32 v23, 31, v0
    v_lshl_add_u32 v24, v23, 4, v24
    s_waitcnt lgkmcnt(0)
    s_barrier
    s_cmp_ge_u32 s38, 2
    s_cbranch_scc1 R_6
    ds_read_b128 v[32:35], v22 offset:0
    ds_read_b128 v[36:39], v22 offset:1024
    ds_read_b128 v[40:43], v22 offset:2048
    ds_read_b128 v[44:47], v22 offset:3072
    s_waitcnt lgkmcnt(2)
    v_pk_add_f32 v[32:33], v[32:33], v[36:37]
    v_pk_add_f32 v[34:35], v[34:35], v[38:39]
    s_waitcnt lgkmcnt(0)
    v_pk_add_f32 v[40:41], v[40:41], v[44:45]
    v_pk_add_f32 v[42:43], v[42:43], v[46:47]
    v_pk_add_f32 v[32:33], v[32:33], v[40:41]
    v_pk_add_f32 v[34:35], v[34:35], v[42:43]
    global_store_dwordx4 v24, v[32:35], s[34:35] sc1
R_6:
    s_branch G_MAIN
ROLE_QI:
    s_cmp_eq_u32 s37, 6
    s_cbranch_scc1 ROLE_I
    s_cmp_lt_u32 s37, 4
    s_cbranch_scc1 QNH
    s_lshl_b32 s41, s36, 10
    s_lshl_b32 s42, s38, 20
    s_add_u32 s41, s41, s42
    s_and_b32 s42, s37, 1
    s_lshl_b32 s42, s42, 19
    s_add_u32 s41, s41, s42
    s_add_u32 s41, s41, 384
    v_lshrrev_b32 v5, 3, v0
    v_lshl_add_u32 v5, v5, 13, s41
    v_lshl_add_u32 v5, v7, 4, v5
    s_waitcnt lgkmcnt(0)
    global_load_dwordx4 v[64:67], v5, s[8:9]
    v_add_u32 v5, 65536, v5
    global_load_dwordx4 v[68:71], v5, s[8:9]
    v_add_u32 v5, 65536, v5
    global_load_dwordx4 v[72:75], v5, s[8:9]
    v_add_u32 v5, 65536, v5
    global_load_dwordx4 v[76:79], v5, s[8:9]
    v_add_u32 v5, -196608, v5
QNH:
    s_waitcnt lgkmcnt(0)
    s_load_dword s63, s[34:35], 261120
    s_mul_i32 s53, s36, 7
    s_add_u32 s53, s53, s37
    s_and_b32 s54, s53, 1
    s_lshr_b32 s55, s53, 1
    s_mul_i32 s57, s54, 28
    s_add_u32 s41, s57, s55
    s_lshl_b32 s41, s41, 11
    s_lshl_b32 s49, s38, 9
    s_add_u32 s41, s41, s49
    s_add_u32 s41, s41, 393216
    v_lshl_add_u32 v8, v0, 3, s41
    global_store_dwordx2 v8, v[28:29], s[34:35] sc1
    s_waitcnt lgkmcnt(0)
    s_mul_i32 s63, s63, 0x9e3779b1
    s_add_u32 s63, s63, 0x7f4a7c15
    s_waitcnt vmcnt(0)
    s_barrier
    s_lshl_b32 s68, s2, 7
    s_add_u32 s68, s68, 229376
    v_add_u32 v8, s68, v1
    v_mov_b32 v9, s63
    s_cmp_eq_u32 s38, 0
    s_cselect_b32 exec_lo, -1, 0
    s_mov_b32 exec_hi, 0
    global_store_dword v8, v9, s[34:35] sc1
    s_mov_b64 exec, -1
    s_lshl_b32 s41, s37, 1
    s_sub_u32 s41, s41, 4
    s_lshr_b32 s42, s36, 1
    s_mov_b32 s41, s37
    s_mov_b32 s43, 6
    s_cmp_eq_u32 s42, 2
    s_cselect_b32 s46, 4, 4
    s_cmp_lg_u32 s42, 3
    s_cbranch_scc1 KH_7s
    s_mov_b32 s46, 4
    s_sub_u32 s41, s37, 4
    s_mov_b32 s43, 4
KH_7s:
    s_lshr_b32 s47, s46, 1
    s_sub_u32 s47, 8, s47
    s_lshl_b32 s46, s46, 3
    s_lshl_b32 s48, s38, 15
    s_add_u32 m0, s48, 16384
    s_lshl_b32 s48, s38, 12
    v_add_u32 v5, s48, v4
KH_7:
    s_cmp_ge_u32 s41, s46
    s_cbranch_scc1 KD_8
    s_lshr_b32 s48, s41, 4
    s_add_u32 s48, s48, s47
    s_and_b32 s49, s41, 8
    s_add_u32 s48, s48, s49
    s_and_b32 s49, s48, 4
    s_lshl_b32 s48, s48, 19
    s_lshl_b32 s49, s49, 16
    s_or_b32 s48, s48, s49
    s_and_b32 s49, s41, 4
    s_lshl_b32 s49, s49, 21
    s_or_b32 s48, s48, s49
    s_and_b32 s49, s41, 3
    s_lshl3_add_u32 s49, s49, s36
    s_lshl_b32 s49, s49, 14
    s_xor_b32 s48, s48, s49
    v_add_u32 v8, s48, v5
    global_load_lds_dwordx4 v8, s[6:7] offset:0
    global_load_lds_dwordx4 v8, s[6:7] offset:1024
    global_load_lds_dwordx4 v8, s[6:7] offset:2048
    global_load_lds_dwordx4 v8, s[6:7] offset:3072
    s_add_u32 s41, s41, s43
    s_branch KH_7
KD_8:
    s_lshl_b32 s49, s2, 7
    s_add_u32 s49, s49, 244736
    v_mov_b32 v30, s49
    s_mov_b32 s69, 65536
FL_9:
    global_load_dword v31, v30, s[34:35] sc1
    s_waitcnt vmcnt(0)
    v_cmp_ne_u32 vcc, s63, v31
    s_cbranch_vccz FD_10
    s_sub_u32 s69, s69, 1
    s_cbranch_scc0 FL_9
FD_10:
    s_cmp_eq_u32 s37, 4
    s_cbranch_scc1 QH4
    s_branch QH5
QH4:
QH5:
    s_mul_i32 s41, s38, 458752
    s_lshl_b32 s42, s55, 7
    s_add_u32 s41, s41, s42
    s_add_u32 s46, s18, s41
    s_addc_u32 s47, s19, 0
    v_lshrrev_b32 v26, 3, v0
    v_mul_u32_u24 v26, 3584, v26
    v_lshl_add_u32 v26, v7, 4, v26
    s_lshl_b32 s48, s38, 15
    s_add_u32 m0, s48, 0
    s_nop 0
    global_load_lds_dwordx4 v26, s[46:47]
    v_add_u32 v26, 28672, v26
    s_add_u32 m0, s48, 1024
    s_nop 0
    global_load_lds_dwordx4 v26, s[46:47]
    v_add_u32 v26, 28672, v26
    s_add_u32 m0, s48, 2048
    s_nop 0
    global_load_lds_dwordx4 v26, s[46:47]
    v_add_u32 v26, 28672, v26
    s_add_u32 m0, s48, 3072
    s_nop 0
    global_load_lds_dwordx4 v26, s[46:47]
    v_add_u32 v26, 28672, v26
    s_add_u32 m0, s48, 4096
    s_nop 0
    global_load_lds_dwordx4 v26, s[46:47]
    v_add_u32 v26, 28672, v26
    s_add_u32 m0, s48, 5120
    s_nop 0
    global_load_lds_dwordx4 v26, s[46:47]
    v_add_u32 v26, 28672, v26
    s_add_u32 m0, s48, 6144
    s_nop 0
    global_load_lds_dwordx4 v26, s[46:47]
    v_add_u32 v26, 28672, v26
    s_add_u32 m0, s48, 7168
    s_nop 0
    global_load_lds_dwordx4 v26, s[46:47]
    v_add_u32 v26, 28672, v26
    s_add_u32 m0, s48, 8192
    s_nop 0
    global_load_lds_dwordx4 v26, s[46:47]
    v_add_u32 v26, 28672, v26
    s_add_u32 m0, s48, 9216
    s_nop 0
    global_load_lds_dwordx4 v26, s[46:47]
    v_add_u32 v26, 28672, v26
    s_add_u32 m0, s48, 10240
    s_nop 0
    global_load_lds_dwordx4 v26, s[46:47]
    v_add_u32 v26, 28672, v26
    s_add_u32 m0, s48, 11264
    s_nop 0
    global_load_lds_dwordx4 v26, s[46:47]
    v_add_u32 v26, 28672, v26
    s_add_u32 m0, s48, 12288
    s_nop 0
    global_load_lds_dwordx4 v26, s[46:47]
    v_add_u32 v26, 28672, v26
    s_add_u32 m0, s48, 13312
    s_nop 0
    global_load_lds_dwordx4 v26, s[46:47]
    v_add_u32 v26, 28672, v26
    s_add_u32 m0, s48, 14336
    s_nop 0
    global_load_lds_dwordx4 v26, s[46:47]
    v_add_u32 v26, 28672, v26
    s_add_u32 m0, s48, 15360
    s_nop 0
    global_load_lds_dwordx4 v26, s[46:47]
    v_add_u32 v26, 28672, v26
    s_branch G_MAIN
ROLE_I:
    s_getpc_b64 s[40:41]
PC0:
    s_sub_u32 s40, s40, PC0-adaLN_cond__compressed_kv_cla__mixer_channel_mlp__decode_kernel
    s_subb_u32 s41, s41, 0
    s_lshl_b32 s42, s38, 10
    v_add_u32 v5, s42, v4
    v_min_u32 v8, CODE_END-adaLN_cond__compressed_kv_cla__mixer_channel_mlp__decode_kernel-16, v5
    global_load_dwordx4 v[32:35], v8, s[40:41]
    v_add_u32 v5, 4096, v5
    v_min_u32 v8, CODE_END-adaLN_cond__compressed_kv_cla__mixer_channel_mlp__decode_kernel-16, v5
    global_load_dwordx4 v[36:39], v8, s[40:41]
    v_add_u32 v5, 4096, v5
    v_min_u32 v8, CODE_END-adaLN_cond__compressed_kv_cla__mixer_channel_mlp__decode_kernel-16, v5
    global_load_dwordx4 v[40:43], v8, s[40:41]
    v_add_u32 v5, 4096, v5
    v_min_u32 v8, CODE_END-adaLN_cond__compressed_kv_cla__mixer_channel_mlp__decode_kernel-16, v5
    global_load_dwordx4 v[44:47], v8, s[40:41]
    v_add_u32 v5, 4096, v5
    v_min_u32 v8, CODE_END-adaLN_cond__compressed_kv_cla__mixer_channel_mlp__decode_kernel-16, v5
    global_load_dwordx4 v[48:51], v8, s[40:41]
    v_add_u32 v5, 4096, v5
    v_min_u32 v8, CODE_END-adaLN_cond__compressed_kv_cla__mixer_channel_mlp__decode_kernel-16, v5
    global_load_dwordx4 v[52:55], v8, s[40:41]
    v_add_u32 v5, 4096, v5
    v_min_u32 v8, CODE_END-adaLN_cond__compressed_kv_cla__mixer_channel_mlp__decode_kernel-16, v5
    global_load_dwordx4 v[56:59], v8, s[40:41]
    v_add_u32 v5, 4096, v5
    s_waitcnt lgkmcnt(0)
    s_load_dword s63, s[34:35], 261120
    s_mul_i32 s53, s36, 7
    s_add_u32 s53, s53, s37
    s_and_b32 s54, s53, 1
    s_lshr_b32 s55, s53, 1
    s_mul_i32 s57, s54, 28
    s_add_u32 s41, s57, s55
    s_lshl_b32 s41, s41, 11
    s_lshl_b32 s49, s38, 9
    s_add_u32 s41, s41, s49
    s_add_u32 s41, s41, 393216
    v_lshl_add_u32 v8, v0, 3, s41
    global_store_dwordx2 v8, v[28:29], s[34:35] sc1
    s_waitcnt lgkmcnt(0)
    s_mul_i32 s63, s63, 0x9e3779b1
    s_add_u32 s63, s63, 0x7f4a7c15
    s_waitcnt vmcnt(0)
    s_barrier
    s_lshl_b32 s68, s2, 7
    s_add_u32 s68, s68, 229376
    v_add_u32 v8, s68, v1
    v_mov_b32 v9, s63
    s_cmp_eq_u32 s38, 0
    s_cselect_b32 exec_lo, -1, 0
    s_mov_b32 exec_hi, 0
    global_store_dword v8, v9, s[34:35] sc1
    s_mov_b64 exec, -1
    s_lshr_b32 s41, 2, 1
    s_lshl_b32 s42, s36, 2
    s_add_u32 s41, s41, s42
    s_lshl_b32 s42, s41, 8
    s_lshl_b32 s43, s38, 20
    s_add_u32 s42, s42, s43
    s_add_u32 s42, s42, 524288
    s_lshl_b32 s41, s41, 17
    s_lshl_b32 s43, s38, 8
    s_add_u32 s41, s41, s43
    s_add_u32 s41, s41, 65536
    s_and_b32 s43, 2, 1
    s_cselect_b32 s41, s41, s42
    s_cselect_b32 s42, 10, 13
    s_cselect_b64 s[44:45], s[14:15], s[12:13]
    s_lshl_b32 s43, 4, s42
    v_lshlrev_b32 v5, s42, v3
    v_lshl_add_u32 v5, v2, 4, v5
    v_add_u32 v5, s41, v5
    global_load_dwordx4 v[64:67], v5, s[44:45]
    v_add_u32 v5, s43, v5
    global_load_dwordx4 v[68:71], v5, s[44:45]
    v_add_u32 v5, s43, v5
    global_load_dwordx4 v[72:75], v5, s[44:45]
    v_add_u32 v5, s43, v5
    global_load_dwordx4 v[76:79], v5, s[44:45]
    v_add_u32 v5, s43, v5
    global_load_dwordx4 v[80:83], v5, s[44:45]
    v_add_u32 v5, s43, v5
    global_load_dwordx4 v[84:87], v5, s[44:45]
    v_add_u32 v5, s43, v5
    global_load_dwordx4 v[88:91], v5, s[44:45]
    v_add_u32 v5, s43, v5
    global_load_dwordx4 v[92:95], v5, s[44:45]
    v_add_u32 v5, s43, v5
    global_load_dwordx4 v[96:99], v5, s[44:45]
    v_add_u32 v5, s43, v5
    global_load_dwordx4 v[100:103], v5, s[44:45]
    v_add_u32 v5, s43, v5
    global_load_dwordx4 v[104:107], v5, s[44:45]
    v_add_u32 v5, s43, v5
    global_load_dwordx4 v[108:111], v5, s[44:45]
    v_add_u32 v5, s43, v5
    global_load_dwordx4 v[112:115], v5, s[44:45]
    v_add_u32 v5, s43, v5
    global_load_dwordx4 v[116:119], v5, s[44:45]
    v_add_u32 v5, s43, v5
    global_load_dwordx4 v[120:123], v5, s[44:45]
    v_add_u32 v5, s43, v5
    global_load_dwordx4 v[124:127], v5, s[44:45]
    v_add_u32 v5, s43, v5
    s_lshl_b32 s49, s2, 7
    s_add_u32 s49, s49, 244736
    v_mov_b32 v30, s49
    s_mov_b32 s69, 65536
FL_11:
    global_load_dword v31, v30, s[34:35] sc1
    s_waitcnt vmcnt(0)
    v_cmp_ne_u32 vcc, s63, v31
    s_cbranch_vccz FD_12
    s_sub_u32 s69, s69, 1
    s_cbranch_scc0 FL_11
FD_12:
    s_mul_i32 s41, s38, 458752
    s_lshl_b32 s42, s55, 7
    s_add_u32 s41, s41, s42
    s_add_u32 s46, s18, s41
    s_addc_u32 s47, s19, 0
    v_lshrrev_b32 v26, 3, v0
    v_mul_u32_u24 v26, 3584, v26
    v_lshl_add_u32 v26, v7, 4, v26
    s_lshl_b32 s48, s38, 15
    s_add_u32 m0, s48, 0
    s_nop 0
    global_load_lds_dwordx4 v26, s[46:47]
    v_add_u32 v26, 28672, v26
    s_add_u32 m0, s48, 1024
    s_nop 0
    global_load_lds_dwordx4 v26, s[46:47]
    v_add_u32 v26, 28672, v26
    s_add_u32 m0, s48, 2048
    s_nop 0
    global_load_lds_dwordx4 v26, s[46:47]
    v_add_u32 v26, 28672, v26
    s_add_u32 m0, s48, 3072
    s_nop 0
    global_load_lds_dwordx4 v26, s[46:47]
    v_add_u32 v26, 28672, v26
    s_add_u32 m0, s48, 4096
    s_nop 0
    global_load_lds_dwordx4 v26, s[46:47]
    v_add_u32 v26, 28672, v26
    s_add_u32 m0, s48, 5120
    s_nop 0
    global_load_lds_dwordx4 v26, s[46:47]
    v_add_u32 v26, 28672, v26
    s_add_u32 m0, s48, 6144
    s_nop 0
    global_load_lds_dwordx4 v26, s[46:47]
    v_add_u32 v26, 28672, v26
    s_add_u32 m0, s48, 7168
    s_nop 0
    global_load_lds_dwordx4 v26, s[46:47]
    v_add_u32 v26, 28672, v26
    s_add_u32 m0, s48, 8192
    s_nop 0
    global_load_lds_dwordx4 v26, s[46:47]
    v_add_u32 v26, 28672, v26
    s_add_u32 m0, s48, 9216
    s_nop 0
    global_load_lds_dwordx4 v26, s[46:47]
    v_add_u32 v26, 28672, v26
    s_add_u32 m0, s48, 10240
    s_nop 0
    global_load_lds_dwordx4 v26, s[46:47]
    v_add_u32 v26, 28672, v26
    s_add_u32 m0, s48, 11264
    s_nop 0
    global_load_lds_dwordx4 v26, s[46:47]
    v_add_u32 v26, 28672, v26
    s_add_u32 m0, s48, 12288
    s_nop 0
    global_load_lds_dwordx4 v26, s[46:47]
    v_add_u32 v26, 28672, v26
    s_add_u32 m0, s48, 13312
    s_nop 0
    global_load_lds_dwordx4 v26, s[46:47]
    v_add_u32 v26, 28672, v26
    s_add_u32 m0, s48, 14336
    s_nop 0
    global_load_lds_dwordx4 v26, s[46:47]
    v_add_u32 v26, 28672, v26
    s_add_u32 m0, s48, 15360
    s_nop 0
    global_load_lds_dwordx4 v26, s[46:47]
    v_add_u32 v26, 28672, v26
G_MAIN:
    s_lshl_b32 s41, s55, 16
    s_lshl_b32 s42, s38, 8
    s_add_u32 s41, s41, s42
    s_add_u32 s41, s41, 4096
    s_add_u32 s44, s22, s41
    s_addc_u32 s45, s23, 0
    v_lshlrev_b32 v5, 13, v3
    v_lshl_add_u32 v5, v2, 4, v5
    global_load_dwordx4 v[64:67], v5, s[44:45] offset:-4096
    global_load_dwordx4 v[68:71], v5, s[44:45] offset:-3072
    global_load_dwordx4 v[72:75], v5, s[44:45] offset:-2048
    global_load_dwordx4 v[76:79], v5, s[44:45] offset:-1024
    global_load_dwordx4 v[80:83], v5, s[44:45] offset:0
    global_load_dwordx4 v[84:87], v5, s[44:45] offset:1024
    global_load_dwordx4 v[88:91], v5, s[44:45] offset:2048
    global_load_dwordx4 v[92:95], v5, s[44:45] offset:3072
    v_add_u32 v5, 32768, v5
    global_load_dwordx4 v[96:99], v5, s[44:45] offset:-4096
    global_load_dwordx4 v[100:103], v5, s[44:45] offset:-3072
    global_load_dwordx4 v[104:107], v5, s[44:45] offset:-2048
    global_load_dwordx4 v[108:111], v5, s[44:45] offset:-1024
    global_load_dwordx4 v[112:115], v5, s[44:45] offset:0
    global_load_dwordx4 v[116:119], v5, s[44:45] offset:1024
    global_load_dwordx4 v[120:123], v5, s[44:45] offset:2048
    global_load_dwordx4 v[124:127], v5, s[44:45] offset:3072
    v_and_b32 v8, 1, v3
    v_lshlrev_b32 v9, 4, v2
    v_lshl_add_u32 v9, v8, 3, v9
    v_add_u32 v9, s42, v9
    s_lshl_b32 s43, s54, 10
    v_add_u32 v10, s43, v9
    global_load_dwordx2 v[24:25], v10, s[4:5]
    s_lshl_b32 s41, s55, 7
    s_lshl_b32 s49, s38, 5
    s_add_u32 s41, s41, s49
    v_lshl_add_u32 v10, v2, 1, s41
    global_load_ushort v22, v10, s[20:21]
    s_and_b32 s56, s55, 15
    s_lshr_b32 s41, s56, 2
    s_lshl_b32 s41, s41, 8
    s_and_b32 s49, s56, 1
    s_lshl_b32 s49, s49, 7
    s_add_u32 s41, s41, s49
    s_and_b32 s49, s56, 2
    s_lshl_b32 s49, s49, 2
    s_add_u32 s41, s41, s49
    v_lshl_add_u32 v23, v7, 4, s41
    global_load_dwordx2 v[20:21], v23, s[24:25]
    v_lshrrev_b32 v10, 2, v2
    v_lshl_add_u32 v10, v3, 3, v10
    v_lshlrev_b32 v10, 7, v10
    v_and_b32 v11, 3, v2
    v_lshl_add_u32 v10, v11, 3, v10
    s_lshl_b32 s49, s38, 5
    v_add_u32 v10, s49, v10
    v_add_u32 v11, 65536, v10
    v_add_u32 v30, 0, v0
    v_min_u32 v30, 55, v30
    v_lshlrev_b32 v30, 7, v30
    v_add_u32 v30, 229376, v30
    global_load_dword v31, v30, s[34:35] sc1
    v_add_u32 v26, 56, v0
    v_min_u32 v26, 119, v26
    v_lshlrev_b32 v26, 7, v26
    v_add_u32 v26, 229376, v26
    global_load_dword v27, v26, s[34:35] sc1
    s_waitcnt vmcnt(21)
    s_barrier
    ds_read_b64_tr_b16 v[128:129], v10 offset:0
    ds_read_b64_tr_b16 v[130:131], v10 offset:512
    ds_read_b64_tr_b16 v[132:133], v10 offset:4096
    ds_read_b64_tr_b16 v[134:135], v10 offset:4608
    ds_read_b64_tr_b16 v[136:137], v10 offset:8192
    ds_read_b64_tr_b16 v[138:139], v10 offset:8704
    ds_read_b64_tr_b16 v[140:141], v10 offset:12288
    ds_read_b64_tr_b16 v[142:143], v10 offset:12800
    ds_read_b64_tr_b16 v[144:145], v10 offset:32768
    ds_read_b64_tr_b16 v[146:147], v10 offset:33280
    ds_read_b64_tr_b16 v[148:149], v10 offset:36864
    ds_read_b64_tr_b16 v[150:151], v10 offset:37376
    ds_read_b64_tr_b16 v[152:153], v10 offset:40960
    ds_read_b64_tr_b16 v[154:155], v10 offset:41472
    ds_read_b64_tr_b16 v[156:157], v10 offset:45056
    ds_read_b64_tr_b16 v[158:159], v10 offset:45568
    ds_read_b64_tr_b16 v[160:161], v11 offset:0
    ds_read_b64_tr_b16 v[162:163], v11 offset:512
    ds_read_b64_tr_b16 v[164:165], v11 offset:4096
    ds_read_b64_tr_b16 v[166:167], v11 offset:4608
    ds_read_b64_tr_b16 v[168:169], v11 offset:8192
    ds_read_b64_tr_b16 v[170:171], v11 offset:8704
    ds_read_b64_tr_b16 v[172:173], v11 offset:12288
    ds_read_b64_tr_b16 v[174:175], v11 offset:12800
    ds_read_b64_tr_b16 v[176:177], v11 offset:32768
    ds_read_b64_tr_b16 v[178:179], v11 offset:33280
    ds_read_b64_tr_b16 v[180:181], v11 offset:36864
    ds_read_b64_tr_b16 v[182:183], v11 offset:37376
    ds_read_b64_tr_b16 v[184:185], v11 offset:40960
    ds_read_b64_tr_b16 v[186:187], v11 offset:41472
    ds_read_b64_tr_b16 v[188:189], v11 offset:45056
    ds_read_b64_tr_b16 v[190:191], v11 offset:45568
    s_waitcnt vmcnt(19)
    v_perm_b32 v192, v68, v64, s66
    v_perm_b32 v196, v68, v64, s67
    v_perm_b32 v200, v69, v65, s66
    v_perm_b32 v204, v69, v65, s67
    v_perm_b32 v208, v70, v66, s66
    v_perm_b32 v212, v70, v66, s67
    v_perm_b32 v216, v71, v67, s66
    v_perm_b32 v220, v71, v67, s67
    s_waitcnt vmcnt(17)
    v_perm_b32 v193, v76, v72, s66
    v_perm_b32 v197, v76, v72, s67
    v_perm_b32 v201, v77, v73, s66
    v_perm_b32 v205, v77, v73, s67
    v_perm_b32 v209, v78, v74, s66
    v_perm_b32 v213, v78, v74, s67
    v_perm_b32 v217, v79, v75, s66
    v_perm_b32 v221, v79, v75, s67
    s_waitcnt vmcnt(15)
    v_perm_b32 v194, v84, v80, s66
    v_perm_b32 v198, v84, v80, s67
    v_perm_b32 v202, v85, v81, s66
    v_perm_b32 v206, v85, v81, s67
    v_perm_b32 v210, v86, v82, s66
    v_perm_b32 v214, v86, v82, s67
    v_perm_b32 v218, v87, v83, s66
    v_perm_b32 v222, v87, v83, s67
    s_waitcnt vmcnt(13)
    v_perm_b32 v195, v92, v88, s66
    v_perm_b32 v199, v92, v88, s67
    v_perm_b32 v203, v93, v89, s66
    v_perm_b32 v207, v93, v89, s67
    v_perm_b32 v211, v94, v90, s66
    v_perm_b32 v215, v94, v90, s67
    v_perm_b32 v219, v95, v91, s66
    v_perm_b32 v223, v95, v91, s67
    s_waitcnt vmcnt(11)
    v_perm_b32 v224, v100, v96, s66
    v_perm_b32 v228, v100, v96, s67
    v_perm_b32 v232, v101, v97, s66
    v_perm_b32 v236, v101, v97, s67
    v_perm_b32 v240, v102, v98, s66
    v_perm_b32 v244, v102, v98, s67
    v_perm_b32 v248, v103, v99, s66
    v_perm_b32 v252, v103, v99, s67
    s_waitcnt vmcnt(9)
    v_perm_b32 v225, v108, v104, s66
    v_perm_b32 v229, v108, v104, s67
    v_perm_b32 v233, v109, v105, s66
    v_perm_b32 v237, v109, v105, s67
    v_perm_b32 v241, v110, v106, s66
    v_perm_b32 v245, v110, v106, s67
    v_perm_b32 v249, v111, v107, s66
    v_perm_b32 v253, v111, v107, s67
    s_waitcnt vmcnt(7)
    v_perm_b32 v226, v116, v112, s66
    v_perm_b32 v230, v116, v112, s67
    v_perm_b32 v234, v117, v113, s66
    v_perm_b32 v238, v117, v113, s67
    v_perm_b32 v242, v118, v114, s66
    v_perm_b32 v246, v118, v114, s67
    v_perm_b32 v250, v119, v115, s66
    v_perm_b32 v254, v119, v115, s67
    s_waitcnt vmcnt(5)
    v_perm_b32 v227, v124, v120, s66
    v_perm_b32 v231, v124, v120, s67
    v_perm_b32 v235, v125, v121, s66
    v_perm_b32 v239, v125, v121, s67
    v_perm_b32 v243, v126, v122, s66
    v_perm_b32 v247, v126, v122, s67
    v_perm_b32 v251, v127, v123, s66
    v_perm_b32 v255, v127, v123, s67
    s_lshl_b32 s41, s54, 13
    s_lshl_b32 s49, s38, 11
    s_add_u32 s41, s41, s49
    s_add_u32 s41, s41, 327680
    v_add_u32 v12, s41, v4
    v_add_u32 v13, 16384, v12
    v_add_u32 v14, 32768, v12
    v_add_u32 v15, 49152, v12
    s_waitcnt vmcnt(1)
    v_cmp_ne_u32 vcc, s63, v31
    s_cbranch_vccz FD_14
    s_mov_b32 s69, 65536
FL_13:
    global_load_dword v31, v30, s[34:35] sc1
    s_waitcnt vmcnt(0)
    v_cmp_ne_u32 vcc, s63, v31
    s_cbranch_vccz FD_14
    s_sub_u32 s69, s69, 1
    s_cbranch_scc0 FL_13
FD_14:
    s_waitcnt vmcnt(0)
    v_cmp_ne_u32 vcc, s63, v27
    s_cbranch_vccz FD_16
    s_mov_b32 s69, 65536
FL_15:
    global_load_dword v27, v26, s[34:35] sc1
    s_waitcnt vmcnt(0)
    v_cmp_ne_u32 vcc, s63, v27
    s_cbranch_vccz FD_16
    s_sub_u32 s69, s69, 1
    s_cbranch_scc0 FL_15
FD_16:
    s_mov_b32 s69, 65536
PL_17:
    global_load_dwordx4 v[64:67], v12, s[34:35] offset:0 sc1
    global_load_dwordx4 v[68:71], v12, s[34:35] offset:1024 sc1
    global_load_dwordx4 v[72:75], v13, s[34:35] offset:0 sc1
    global_load_dwordx4 v[76:79], v13, s[34:35] offset:1024 sc1
    global_load_dwordx4 v[80:83], v14, s[34:35] offset:0 sc1
    global_load_dwordx4 v[84:87], v14, s[34:35] offset:1024 sc1
    global_load_dwordx4 v[88:91], v15, s[34:35] offset:0 sc1
    global_load_dwordx4 v[92:95], v15, s[34:35] offset:1024 sc1
PC_18:
    s_waitcnt vmcnt(7)
    v_max_u32 v8, v64, v65
    v_max3_u32 v8, v8, v66, v67
    s_waitcnt vmcnt(6)
    v_max3_u32 v8, v8, v68, v69
    v_max3_u32 v8, v8, v70, v71
    s_waitcnt vmcnt(5)
    v_max3_u32 v8, v8, v72, v73
    v_max3_u32 v8, v8, v74, v75
    s_waitcnt vmcnt(4)
    v_max3_u32 v8, v8, v76, v77
    v_max3_u32 v8, v8, v78, v79
    s_waitcnt vmcnt(3)
    v_max3_u32 v8, v8, v80, v81
    v_max3_u32 v8, v8, v82, v83
    s_waitcnt vmcnt(2)
    v_max3_u32 v8, v8, v84, v85
    v_max3_u32 v8, v8, v86, v87
    s_waitcnt vmcnt(1)
    v_max3_u32 v8, v8, v88, v89
    v_max3_u32 v8, v8, v90, v91
    s_waitcnt vmcnt(0)
    v_max3_u32 v8, v8, v92, v93
    v_max3_u32 v8, v8, v94, v95
    v_cmp_eq_u32 vcc, -1, v8
    s_cbranch_vccz PD_19
    s_sub_u32 s69, s69, 1
    s_cbranch_scc0 PL_17
PD_19:
    v_pk_add_f32 v[64:65], v[64:65], v[72:73]
    v_pk_add_f32 v[80:81], v[80:81], v[88:89]
    v_pk_add_f32 v[64:65], v[64:65], v[80:81]
    v_pk_add_f32 v[66:67], v[66:67], v[74:75]
    v_pk_add_f32 v[82:83], v[82:83], v[90:91]
    v_pk_add_f32 v[66:67], v[66:67], v[82:83]
    v_pk_add_f32 v[68:69], v[68:69], v[76:77]
    v_pk_add_f32 v[84:85], v[84:85], v[92:93]
    v_pk_add_f32 v[68:69], v[68:69], v[84:85]
    v_pk_add_f32 v[70:71], v[70:71], v[78:79]
    v_pk_add_f32 v[86:87], v[86:87], v[94:95]
    v_pk_add_f32 v[70:71], v[70:71], v[86:87]
    s_cmp_eq_u32 s38, 2
    s_cselect_b32 s41, 1.0, 0
    v_add_f32 v64, s41, v64
    v_add_f32 v65, s41, v65
    v_add_f32 v66, s41, v66
    v_add_f32 v67, s41, v67
    v_add_f32 v68, s41, v68
    v_add_f32 v69, s41, v69
    v_add_f32 v70, s41, v70
    v_add_f32 v71, s41, v71
    s_add_u32 s49, s49, 131072
    v_add_u32 v12, s49, v4
    ds_write_b128 v12, v[64:67]
    ds_write_b128 v12, v[68:71] offset:1024
    s_mul_i32 s49, s38, 2176
    s_add_u32 s49, s49, 139264
    v_lshl_add_u32 v12, v0, 3, s49
    v_cvt_pk_bf16_f32 v72, v64, v65
    v_cvt_pk_bf16_f32 v73, v66, v67
    v_cvt_pk_bf16_f32 v74, v68, v69
    v_cvt_pk_bf16_f32 v75, v70, v71
    v_lshlrev_b32 v80, 16, v72
    v_and_b32 v81, 0xffff0000, v72
    v_sub_f32 v80, v64, v80
    v_sub_f32 v81, v65, v81
    v_cvt_pk_bf16_f32 v76, v80, v81
    v_lshlrev_b32 v80, 16, v73
    v_and_b32 v81, 0xffff0000, v73
    v_sub_f32 v80, v66, v80
    v_sub_f32 v81, v67, v81
    v_cvt_pk_bf16_f32 v77, v80, v81
    v_lshlrev_b32 v80, 16, v74
    v_and_b32 v81, 0xffff0000, v74
    v_sub_f32 v80, v68, v80
    v_sub_f32 v81, v69, v81
    v_cvt_pk_bf16_f32 v78, v80, v81
    v_lshlrev_b32 v80, 16, v75
    v_and_b32 v81, 0xffff0000, v75
    v_sub_f32 v80, v70, v80
    v_sub_f32 v81, v71, v81
    v_cvt_pk_bf16_f32 v79, v80, v81
    ds_write_b64 v12, v[72:73]
    ds_write_b64 v12, v[74:75] offset:512
    ds_write_b64 v12, v[76:77] offset:1088
    ds_write_b64 v12, v[78:79] offset:1600
    v_and_b32 v12, 3, v2
    v_mul_u32_u24 v12, 1088, v12
    v_lshl_add_u32 v12, v3, 4, v12
    v_add_u32 v12, 141440, v12
    v_lshlrev_b32 v13, 1, v9
    v_add_u32 v13, 131072, v13
    v_lshlrev_b32 v14, 5, v0
    v_add_u32 v14, 131072, v14
    v_lshlrev_b32 v15, 1, v23
    v_add_u32 v15, 131072, v15
    v_mov_b32 v60, 0x3f803f80
    v_mov_b32 v61, 0x3f803f80
    v_mov_b32 v62, 0x3f803f80
    v_mov_b32 v63, 0x3f803f80
    s_waitcnt lgkmcnt(0)
    s_barrier
    ds_read_b128 v[64:67], v12 offset:0
    ds_read_b128 v[68:71], v12 offset:64
    ds_read_b128 v[72:75], v12 offset:128
    ds_read_b128 v[76:79], v12 offset:192
    ds_read_b128 v[80:83], v12 offset:256
    ds_read_b128 v[84:87], v12 offset:320
    ds_read_b128 v[88:91], v12 offset:384
    ds_read_b128 v[92:95], v12 offset:448
    ds_read_b128 v[96:99], v12 offset:512
    ds_read_b128 v[100:103], v12 offset:576
    ds_read_b128 v[104:107], v12 offset:640
    ds_read_b128 v[108:111], v12 offset:704
    ds_read_b128 v[112:115], v12 offset:768
    ds_read_b128 v[116:119], v12 offset:832
    ds_read_b128 v[120:123], v12 offset:896
    ds_read_b128 v[124:127], v12 offset:960
    v_mfma_f32_16x16x32_bf16 v[56:59], v[60:63], v[128:131], 0
    s_waitcnt lgkmcnt(15)
    v_mfma_f32_16x16x32_bf16 v[52:55], v[64:67], v[128:131], 0
    v_mfma_f32_16x16x32_bf16 v[56:59], v[60:63], v[132:135], v[56:59]
    s_waitcnt lgkmcnt(14)
    v_mfma_f32_16x16x32_bf16 v[52:55], v[68:71], v[132:135], v[52:55]
    v_mfma_f32_16x16x32_bf16 v[56:59], v[60:63], v[136:139], v[56:59]
    s_waitcnt lgkmcnt(13)
    v_mfma_f32_16x16x32_bf16 v[52:55], v[72:75], v[136:139], v[52:55]
    v_mfma_f32_16x16x32_bf16 v[56:59], v[60:63], v[140:143], v[56:59]
    s_waitcnt lgkmcnt(12)
    v_mfma_f32_16x16x32_bf16 v[52:55], v[76:79], v[140:143], v[52:55]
    v_mfma_f32_16x16x32_bf16 v[56:59], v[60:63], v[144:147], v[56:59]
    s_waitcnt lgkmcnt(11)
    v_mfma_f32_16x16x32_bf16 v[52:55], v[80:83], v[144:147], v[52:55]
    v_mfma_f32_16x16x32_bf16 v[56:59], v[60:63], v[148:151], v[56:59]
    s_waitcnt lgkmcnt(10)
    v_mfma_f32_16x16x32_bf16 v[52:55], v[84:87], v[148:151], v[52:55]
    v_mfma_f32_16x16x32_bf16 v[56:59], v[60:63], v[152:155], v[56:59]
    s_waitcnt lgkmcnt(9)
    v_mfma_f32_16x16x32_bf16 v[52:55], v[88:91], v[152:155], v[52:55]
    v_mfma_f32_16x16x32_bf16 v[56:59], v[60:63], v[156:159], v[56:59]
    s_waitcnt lgkmcnt(8)
    v_mfma_f32_16x16x32_bf16 v[52:55], v[92:95], v[156:159], v[52:55]
    v_mfma_f32_16x16x32_bf16 v[56:59], v[60:63], v[160:163], v[56:59]
    s_waitcnt lgkmcnt(7)
    v_mfma_f32_16x16x32_bf16 v[52:55], v[96:99], v[160:163], v[52:55]
    v_mfma_f32_16x16x32_bf16 v[56:59], v[60:63], v[164:167], v[56:59]
    s_waitcnt lgkmcnt(6)
    v_mfma_f32_16x16x32_bf16 v[52:55], v[100:103], v[164:167], v[52:55]
    v_mfma_f32_16x16x32_bf16 v[56:59], v[60:63], v[168:171], v[56:59]
    s_waitcnt lgkmcnt(5)
    v_mfma_f32_16x16x32_bf16 v[52:55], v[104:107], v[168:171], v[52:55]
    v_mfma_f32_16x16x32_bf16 v[56:59], v[60:63], v[172:175], v[56:59]
    s_waitcnt lgkmcnt(4)
    v_mfma_f32_16x16x32_bf16 v[52:55], v[108:111], v[172:175], v[52:55]
    v_mfma_f32_16x16x32_bf16 v[56:59], v[60:63], v[176:179], v[56:59]
    s_waitcnt lgkmcnt(3)
    v_mfma_f32_16x16x32_bf16 v[52:55], v[112:115], v[176:179], v[52:55]
    v_mfma_f32_16x16x32_bf16 v[56:59], v[60:63], v[180:183], v[56:59]
    s_waitcnt lgkmcnt(2)
    v_mfma_f32_16x16x32_bf16 v[52:55], v[116:119], v[180:183], v[52:55]
    v_mfma_f32_16x16x32_bf16 v[56:59], v[60:63], v[184:187], v[56:59]
    s_waitcnt lgkmcnt(1)
    v_mfma_f32_16x16x32_bf16 v[52:55], v[120:123], v[184:187], v[52:55]
    v_mfma_f32_16x16x32_bf16 v[56:59], v[60:63], v[188:191], v[56:59]
    s_waitcnt lgkmcnt(0)
    v_mfma_f32_16x16x32_bf16 v[52:55], v[124:127], v[188:191], v[52:55]
    ds_read_b128 v[32:35], v13
    ds_read_b128 v[36:39], v13 offset:4096
    ds_read_b128 v[40:43], v14 offset:2048
    ds_read_b128 v[44:47], v14 offset:2064
    ds_read_b128 v[16:19], v15 offset:6144
    s_nop 2
    v_add_f32 v52, v52, v53
    v_add_f32 v53, v54, v55
    v_mov_b32 v54, v56
    v_lshlrev_b32 v22, 16, v22
    ds_read_b128 v[56:59], v14 offset:4096
    ds_read_b128 v[60:63], v14 offset:4112
    v_and_b32 v8, 1, v2
    v_lshlrev_b32 v8, 4, v8
    v_mov_b32 v51, 16256
    v_lshlrev_b32 v51, v8, v51
    v_bfe_u32 v8, v2, 1, 2
    v_cmp_eq_u32 vcc, 0, v8
    s_nop 1
    v_cndmask_b32 v48, 0, v51, vcc
    v_cmp_eq_u32 vcc, 1, v8
    s_nop 1
    v_cndmask_b32 v49, 0, v51, vcc
    v_cmp_eq_u32 vcc, 2, v8
    s_nop 1
    v_cndmask_b32 v50, 0, v51, vcc
    v_cmp_eq_u32 vcc, 3, v8
    s_nop 1
    v_cndmask_b32 v51, 0, v51, vcc
    v_lshlrev_b32 v26, 16, v24
    v_and_b32 v27, 0xffff0000, v24
    v_lshlrev_b32 v28, 16, v25
    v_and_b32 v29, 0xffff0000, v25
    s_lshl_b32 s41, s54, 15
    s_add_u32 s41, s41, s42
    s_add_u32 s41, s41, 524288
    s_mul_i32 s49, s54, 384
    s_add_u32 s49, s49, 393088
    s_cmp_eq_u32 s38, 1
    s_cselect_b32 s49, s49, 0
    s_add_u32 s41, s41, s49
    v_lshlrev_b32 v5, 10, v3
    v_lshl_add_u32 v5, v2, 4, v5
    v_add_u32 v5, s41, v5
    v_add_u32 v104, 4096, v5
    v_add_u32 v105, 12288, v5
    v_add_u32 v106, 20480, v5
    v_add_u32 v107, 28672, v5
    v_lshrrev_b32 v10, 1, v3
    v_mul_u32_u24 v10, 1088, v10
    v_add_u32 v10, v9, v10
    v_add_u32 v10, 150016, v10
    v_and_b32 v11, 1, v2
    v_mul_u32_u24 v11, 1088, v11
    v_lshl_add_u32 v11, v3, 4, v11
    v_add_u32 v11, 150016, v11
    v_cmp_le_u32 s[58:59], 32, v0
    v_and_b32 v8, 16, v0
    v_cmp_ne_u32 s[60:61], 0, v8
    s_lshl_b32 s49, s38, 5
    s_add_u32 s49, s49, 152192
    v_lshl_add_u32 v24, v2, 1, s49
    v_lshlrev_b32 v25, 4, v3
    v_add_u32 v25, 152192, v25
    s_add_u32 s41, s57, s55
    s_lshl_b32 s41, s41, 11
    s_lshl_b32 s49, s38, 9
    s_add_u32 s41, s41, s49
    s_add_u32 s41, s41, 393216
    v_add_u32 v30, s41, v4
    s_mov_b32 s62, 0xbdd2d3e8
    v_mov_b32 v55, 0xc0135761
    s_waitcnt lgkmcnt(0)
    s_lshl_b32 s41, s38, 8
    s_add_u32 s41, s41, s2
    s_cmp_lg_u32 s41, 304
    s_cbranch_scc1 NOEPO
    v_add_u32 v64, 120, v0
    v_min_u32 v64, 247, v64
    v_lshlrev_b32 v64, 7, v64
    v_add_u32 v64, 229376, v64
    global_load_dword v65, v64, s[34:35] sc1
    v_add_u32 v66, 184, v0
    v_min_u32 v66, 247, v66
    v_lshlrev_b32 v66, 7, v66
    v_add_u32 v66, 229376, v66
    global_load_dword v67, v66, s[34:35] sc1
    s_waitcnt vmcnt(1)
    v_cmp_ne_u32 vcc, s63, v65
    s_cbranch_vccz FD_21
    s_mov_b32 s69, 65536
FL_20:
    global_load_dword v65, v64, s[34:35] sc1
    s_waitcnt vmcnt(0)
    v_cmp_ne_u32 vcc, s63, v65
    s_cbranch_vccz FD_21
    s_sub_u32 s69, s69, 1
    s_cbranch_scc0 FL_20
FD_21:
    s_waitcnt vmcnt(0)
    v_cmp_ne_u32 vcc, s63, v67
    s_cbranch_vccz FD_23
    s_mov_b32 s69, 65536
FL_22:
    global_load_dword v67, v66, s[34:35] sc1
    s_waitcnt vmcnt(0)
    v_cmp_ne_u32 vcc, s63, v67
    s_cbranch_vccz FD_23
    s_sub_u32 s69, s69, 1
    s_cbranch_scc0 FL_22
FD_23:
    v_mov_b32 v64, 261120
    v_mov_b32 v65, s63
    s_mov_b64 exec, 1
    global_store_dword v64, v65, s[34:35] sc1
    s_mov_b64 exec, -1
NOEPO:
    s_mov_b32 s69, 65536
PL_24:
    global_load_dwordx4 v[64:67], v104, s[34:35] offset:-4096 sc1
    global_load_dwordx4 v[68:71], v104, s[34:35] offset:0 sc1
    global_load_dwordx4 v[72:75], v105, s[34:35] offset:-4096 sc1
    global_load_dwordx4 v[76:79], v105, s[34:35] offset:0 sc1
    global_load_dwordx4 v[80:83], v106, s[34:35] offset:-4096 sc1
    global_load_dwordx4 v[84:87], v106, s[34:35] offset:0 sc1
    global_load_dwordx4 v[88:91], v107, s[34:35] offset:-4096 sc1
    global_load_dwordx4 v[92:95], v107, s[34:35] offset:0 sc1
PC_25:
    s_waitcnt vmcnt(7)
    v_max_u32 v8, v64, v65
    v_max3_u32 v8, v8, v66, v67
    s_waitcnt vmcnt(6)
    v_max3_u32 v8, v8, v68, v69
    v_max3_u32 v8, v8, v70, v71
    s_waitcnt vmcnt(5)
    v_max3_u32 v8, v8, v72, v73
    v_max3_u32 v8, v8, v74, v75
    s_waitcnt vmcnt(4)
    v_max3_u32 v8, v8, v76, v77
    v_max3_u32 v8, v8, v78, v79
    s_waitcnt vmcnt(3)
    v_max3_u32 v8, v8, v80, v81
    v_max3_u32 v8, v8, v82, v83
    s_waitcnt vmcnt(2)
    v_max3_u32 v8, v8, v84, v85
    v_max3_u32 v8, v8, v86, v87
    s_waitcnt vmcnt(1)
    v_max3_u32 v8, v8, v88, v89
    v_max3_u32 v8, v8, v90, v91
    s_waitcnt vmcnt(0)
    v_max3_u32 v8, v8, v92, v93
    v_max3_u32 v8, v8, v94, v95
    v_cmp_eq_u32 vcc, -1, v8
    s_cbranch_vccz PD_26
    s_sub_u32 s69, s69, 1
    s_cbranch_scc0 PL_24
PD_26:
    v_mfma_f32_16x16x32_bf16 v[96:99], v[48:51], v[64:67], 0
    v_mfma_f32_16x16x32_bf16 v[100:103], v[48:51], v[68:71], 0
    v_mfma_f32_16x16x32_bf16 v[96:99], v[48:51], v[72:75], v[96:99]
    v_mfma_f32_16x16x32_bf16 v[100:103], v[48:51], v[76:79], v[100:103]
    v_mfma_f32_16x16x32_bf16 v[96:99], v[48:51], v[80:83], v[96:99]
    v_mfma_f32_16x16x32_bf16 v[100:103], v[48:51], v[84:87], v[100:103]
    v_mfma_f32_16x16x32_bf16 v[96:99], v[48:51], v[88:91], v[96:99]
    v_mfma_f32_16x16x32_bf16 v[100:103], v[48:51], v[92:95], v[100:103]
    s_nop 7
    v_pk_add_f32 v[96:97], v[96:97], v[100:101]
    v_pk_add_f32 v[98:99], v[98:99], v[102:103]
    v_pk_fma_f32 v[96:97], v[96:97], v[32:33], v[26:27]
    v_pk_fma_f32 v[98:99], v[98:99], v[34:35], v[28:29]
    v_pk_mul_f32 v[100:101], v[96:97], v[36:37]
    v_pk_mul_f32 v[102:103], v[98:99], v[38:39]
    ds_write_b128 v13, v[96:99] offset:16896
    v_cvt_pk_bf16_f32 v104, v100, v101
    v_cvt_pk_bf16_f32 v105, v102, v103
    v_lshlrev_b32 v106, 16, v104
    v_and_b32 v107, 0xffff0000, v104
    v_lshlrev_b32 v108, 16, v105
    v_and_b32 v109, 0xffff0000, v105
    v_pk_add_f32 v[100:101], v[100:101], v[106:107] neg_lo:[0,1] neg_hi:[0,1]
    v_pk_add_f32 v[102:103], v[102:103], v[108:109] neg_lo:[0,1] neg_hi:[0,1]
    v_cvt_pk_bf16_f32 v106, v100, v101
    v_cvt_pk_bf16_f32 v107, v102, v103
    v_cndmask_b32 v104, v104, v106, s[58:59]
    v_cndmask_b32 v105, v105, v107, s[58:59]
    ds_write_b64 v10, v[104:105]
    s_waitcnt lgkmcnt(0)
    s_barrier
    ds_read_b128 v[32:35], v14 offset:16896
    ds_read_b128 v[36:39], v14 offset:16912
    ds_read_b128 v[64:67], v11 offset:0
    ds_read_b128 v[68:71], v11 offset:64
    ds_read_b128 v[72:75], v11 offset:128
    ds_read_b128 v[76:79], v11 offset:192
    ds_read_b128 v[80:83], v11 offset:256
    ds_read_b128 v[84:87], v11 offset:320
    ds_read_b128 v[88:91], v11 offset:384
    ds_read_b128 v[92:95], v11 offset:448
    ds_read_b128 v[96:99], v11 offset:512
    ds_read_b128 v[100:103], v11 offset:576
    ds_read_b128 v[104:107], v11 offset:640
    ds_read_b128 v[108:111], v11 offset:704
    ds_read_b128 v[112:115], v11 offset:768
    ds_read_b128 v[116:119], v11 offset:832
    ds_read_b128 v[120:123], v11 offset:896
    ds_read_b128 v[124:127], v11 offset:960
    s_waitcnt lgkmcnt(15)
    v_pk_add_f32 v[26:27], v[32:33], v[34:35]
    v_pk_mul_f32 v[28:29], v[32:33], v[32:33]
    v_pk_add_f32 v[26:27], v[26:27], v[36:37]
    v_pk_fma_f32 v[28:29], v[34:35], v[34:35], v[28:29]
    v_pk_add_f32 v[26:27], v[26:27], v[38:39]
    v_pk_fma_f32 v[28:29], v[36:37], v[36:37], v[28:29]
    v_mfma_f32_16x16x32_bf16 v[8:11], v[64:67], v[128:131], 0
    v_add_f32 v26, v26, v27
    v_pk_fma_f32 v[28:29], v[38:39], v[38:39], v[28:29]
    v_add_f32 v28, v28, v29
    v_add_f32_dpp v26, v26, v26 row_ror:8 row_mask:0xf bank_mask:0xf
    s_nop 0
    v_add_f32_dpp v28, v28, v28 row_ror:8 row_mask:0xf bank_mask:0xf
    v_add_f32_dpp v26, v26, v26 row_ror:4 row_mask:0xf bank_mask:0xf
    s_waitcnt lgkmcnt(14)
    v_mfma_f32_16x16x32_bf16 v[48:51], v[68:71], v[132:135], 0
    v_add_f32_dpp v28, v28, v28 row_ror:4 row_mask:0xf bank_mask:0xf
    v_add_f32_dpp v26, v26, v26 row_ror:2 row_mask:0xf bank_mask:0xf
    s_nop 0
    v_add_f32_dpp v28, v28, v28 row_ror:2 row_mask:0xf bank_mask:0xf
    v_add_f32_dpp v26, v26, v26 row_ror:1 row_mask:0xf bank_mask:0xf
    s_nop 0
    v_add_f32_dpp v28, v28, v28 row_ror:1 row_mask:0xf bank_mask:0xf
    v_mov_b32 v27, v26
    s_waitcnt lgkmcnt(13)
    v_mfma_f32_16x16x32_bf16 v[8:11], v[72:75], v[136:139], v[8:11]
    v_mov_b32 v29, v28
    v_permlane16_swap_b32 v26, v27
    s_nop 0
    v_permlane16_swap_b32 v28, v29
    v_add_f32 v26, v26, v27
    v_add_f32 v28, v28, v29
    v_mov_b32 v27, v26
    s_waitcnt lgkmcnt(12)
    v_mfma_f32_16x16x32_bf16 v[48:51], v[76:79], v[140:143], v[48:51]
    v_mov_b32 v29, v28
    v_permlane32_swap_b32 v26, v27
    s_nop 0
    v_permlane32_swap_b32 v28, v29
    v_add_f32 v26, v26, v27
    v_add_f32 v28, v28, v29
    v_mul_f32 v26, 0x3b000000, v26
    s_waitcnt lgkmcnt(11)
    v_mfma_f32_16x16x32_bf16 v[8:11], v[80:83], v[144:147], v[8:11]
    v_mul_f32 v27, v26, v26
    v_fma_f32 v28, v28, s65, -v27
    v_max_f32 v28, 0, v28
    v_add_f32 v28, 0x3727c5ac, v28
    v_rsq_f32 v28, v28
    v_pk_add_f32 v[32:33], v[32:33], v[26:27] op_sel_hi:[1,0] neg_lo:[0,1] neg_hi:[0,1]
    s_waitcnt lgkmcnt(10)
    v_mfma_f32_16x16x32_bf16 v[48:51], v[84:87], v[148:151], v[48:51]
    v_pk_add_f32 v[34:35], v[34:35], v[26:27] op_sel_hi:[1,0] neg_lo:[0,1] neg_hi:[0,1]
    v_pk_add_f32 v[36:37], v[36:37], v[26:27] op_sel_hi:[1,0] neg_lo:[0,1] neg_hi:[0,1]
    v_pk_add_f32 v[38:39], v[38:39], v[26:27] op_sel_hi:[1,0] neg_lo:[0,1] neg_hi:[0,1]
    v_pk_mul_f32 v[56:57], v[56:57], v[28:29] op_sel_hi:[1,0]
    v_pk_mul_f32 v[58:59], v[58:59], v[28:29] op_sel_hi:[1,0]
    v_pk_mul_f32 v[60:61], v[60:61], v[28:29] op_sel_hi:[1,0]
    s_waitcnt lgkmcnt(9)
    v_mfma_f32_16x16x32_bf16 v[8:11], v[88:91], v[152:155], v[8:11]
    v_pk_mul_f32 v[62:63], v[62:63], v[28:29] op_sel_hi:[1,0]
    v_mul_f32 v53, v53, v26
    v_mov_b32 v31, v28
    v_pk_fma_f32 v[32:33], v[32:33], v[56:57], v[40:41]
    v_pk_fma_f32 v[34:35], v[34:35], v[58:59], v[42:43]
    v_pk_fma_f32 v[36:37], v[36:37], v[60:61], v[44:45]
    s_waitcnt lgkmcnt(8)
    v_mfma_f32_16x16x32_bf16 v[48:51], v[92:95], v[156:159], v[48:51]
    v_pk_fma_f32 v[38:39], v[38:39], v[62:63], v[46:47]
    v_pk_add_f32 v[26:27], v[32:33], v[34:35]
    v_pk_mul_f32 v[28:29], v[32:33], v[32:33]
    v_pk_add_f32 v[26:27], v[26:27], v[36:37]
    v_pk_fma_f32 v[28:29], v[34:35], v[34:35], v[28:29]
    v_pk_add_f32 v[26:27], v[26:27], v[38:39]
    s_waitcnt lgkmcnt(7)
    v_mfma_f32_16x16x32_bf16 v[8:11], v[96:99], v[160:163], v[8:11]
    v_pk_fma_f32 v[28:29], v[36:37], v[36:37], v[28:29]
    v_add_f32 v26, v26, v27
    v_pk_fma_f32 v[28:29], v[38:39], v[38:39], v[28:29]
    v_add_f32 v28, v28, v29
    v_add_f32_dpp v26, v26, v26 row_ror:8 row_mask:0xf bank_mask:0xf
    s_nop 0
    v_add_f32_dpp v28, v28, v28 row_ror:8 row_mask:0xf bank_mask:0xf
    s_waitcnt lgkmcnt(6)
    v_mfma_f32_16x16x32_bf16 v[48:51], v[100:103], v[164:167], v[48:51]
    v_add_f32_dpp v26, v26, v26 row_ror:4 row_mask:0xf bank_mask:0xf
    v_add_f32_dpp v28, v28, v28 row_ror:4 row_mask:0xf bank_mask:0xf
    s_nop 0
    v_add_f32_dpp v26, v26, v26 row_ror:2 row_mask:0xf bank_mask:0xf
    v_add_f32_dpp v28, v28, v28 row_ror:2 row_mask:0xf bank_mask:0xf
    s_nop 0
    v_add_f32_dpp v26, v26, v26 row_ror:1 row_mask:0xf bank_mask:0xf
    v_add_f32_dpp v28, v28, v28 row_ror:1 row_mask:0xf bank_mask:0xf
    s_waitcnt lgkmcnt(5)
    v_mfma_f32_16x16x32_bf16 v[8:11], v[104:107], v[168:171], v[8:11]
    v_mov_b32 v27, v26
    v_mov_b32 v29, v28
    s_nop 0
    v_permlane16_swap_b32 v26, v27
    v_permlane16_swap_b32 v28, v29
    v_add_f32 v26, v26, v27
    v_add_f32 v28, v28, v29
    s_waitcnt lgkmcnt(4)
    v_mfma_f32_16x16x32_bf16 v[48:51], v[108:111], v[172:175], v[48:51]
    v_mov_b32 v27, v26
    v_mov_b32 v29, v28
    s_nop 0
    v_permlane32_swap_b32 v26, v27
    v_permlane32_swap_b32 v28, v29
    v_add_f32 v26, v26, v27
    v_add_f32 v28, v28, v29
    s_waitcnt lgkmcnt(3)
    v_mfma_f32_16x16x32_bf16 v[8:11], v[112:115], v[176:179], v[8:11]
    v_mul_f32 v26, 0x3b000000, v26
    v_mul_f32 v27, v26, v26
    v_fma_f32 v28, v28, s65, -v27
    v_max_f32 v28, 0, v28
    v_add_f32 v28, 0x3727c5ac, v28
    v_rsq_f32 v28, v28
    s_waitcnt lgkmcnt(2)
    v_mfma_f32_16x16x32_bf16 v[48:51], v[116:119], v[180:183], v[48:51]
    v_fma_f32 v52, -v26, v54, v52
    s_waitcnt lgkmcnt(1)
    v_mfma_f32_16x16x32_bf16 v[8:11], v[120:123], v[184:187], v[8:11]
    s_waitcnt lgkmcnt(0)
    v_mfma_f32_16x16x32_bf16 v[48:51], v[124:127], v[188:191], v[48:51]
    s_nop 5
    v_add_f32 v8, v8, v9
    s_nop 0
    v_add_f32 v48, v48, v49
    v_sub_f32 v8, v8, v53
    v_add_f32 v8, v8, v48
    v_fma_f32 v8, v8, v31, v52
    v_fma_f32 v8, v8, v28, v22
    v_mul_f32 v9, v8, v8
    v_fma_f32 v9, v9, s62, v55
    v_mul_f32 v9, v9, v8
    v_exp_f32 v9, v9
    s_nop 0
    v_add_f32 v9, 1.0, v9
    v_rcp_f32 v9, v9
    s_nop 0
    v_mul_f32 v8, v8, v9
    v_cvt_pk_bf16_f32 v8, v8, v8
    ds_write_b16 v24, v8
    s_waitcnt lgkmcnt(0)
    s_barrier
    ds_read_b128 v[32:35], v25
    ds_read_b128 v[36:39], v25 offset:64
    s_waitcnt lgkmcnt(1)
    v_mfma_f32_16x16x32_bf16 v[64:67], v[32:35], v[192:195], 0
    v_mfma_f32_16x16x32_bf16 v[80:83], v[32:35], v[208:211], 0
    v_mfma_f32_16x16x32_bf16 v[68:71], v[32:35], v[196:199], 0
    v_mfma_f32_16x16x32_bf16 v[84:87], v[32:35], v[212:215], 0
    v_mfma_f32_16x16x32_bf16 v[72:75], v[32:35], v[200:203], 0
    v_mfma_f32_16x16x32_bf16 v[88:91], v[32:35], v[216:219], 0
    v_mfma_f32_16x16x32_bf16 v[76:79], v[32:35], v[204:207], 0
    v_mfma_f32_16x16x32_bf16 v[92:95], v[32:35], v[220:223], 0
    s_waitcnt lgkmcnt(0)
    v_mfma_f32_16x16x32_bf16 v[64:67], v[36:39], v[224:227], v[64:67]
    v_mfma_f32_16x16x32_bf16 v[80:83], v[36:39], v[240:243], v[80:83]
    v_mfma_f32_16x16x32_bf16 v[68:71], v[36:39], v[228:231], v[68:71]
    v_mfma_f32_16x16x32_bf16 v[84:87], v[36:39], v[244:247], v[84:87]
    v_mfma_f32_16x16x32_bf16 v[72:75], v[36:39], v[232:235], v[72:75]
    v_mfma_f32_16x16x32_bf16 v[88:91], v[36:39], v[248:251], v[88:91]
    v_mfma_f32_16x16x32_bf16 v[76:79], v[36:39], v[236:239], v[76:79]
    v_mfma_f32_16x16x32_bf16 v[92:95], v[36:39], v[252:255], v[92:95]
    s_nop 1
    v_cndmask_b32 v40, v64, v80, s[60:61]
    s_nop 0
    v_cndmask_b32 v41, v68, v84, s[60:61]
    s_nop 0
    v_cndmask_b32 v42, v72, v88, s[60:61]
    s_nop 0
    v_cndmask_b32 v43, v76, v92, s[60:61]
    s_mov_b32 exec_hi, 0
    global_store_dwordx4 v30, v[40:43], s[34:35] sc1
    s_mov_b32 exec_hi, -1
    s_cmp_lg_u32 s38, 0
    s_cbranch_scc1 FIN
    s_cmp_ge_u32 s55, 16
    s_cbranch_scc1 FIN
    s_lshl_b32 s41, s57, 11
    s_lshl_b32 s49, s55, 7
    s_add_u32 s41, s41, s49
    s_add_u32 s41, s41, 393216
    v_lshrrev_b32 v8, 3, v0
    v_lshl_add_u32 v9, v7, 4, s41
    v_lshl_add_u32 v10, v8, 11, v9
    v_add_u32 v11, 16384, v10
    v_add_u32 v12, 32768, v10
    v_and_b32 v8, 3, v8
    v_lshl_add_u32 v13, v8, 11, v9
    v_add_u32 v13, 49152, v13
    ds_read_b128 v[32:35], v15 offset:16896
    v_lshlrev_b32 v36, 16, v20
    v_and_b32 v37, 0xffff0000, v20
    v_lshlrev_b32 v38, 16, v21
    v_and_b32 v39, 0xffff0000, v21
    v_add_u32 v23, s43, v23
    s_waitcnt lgkmcnt(0)
    v_pk_fma_f32 v[32:33], v[36:37], v[16:17], v[32:33]
    v_pk_fma_f32 v[34:35], v[38:39], v[18:19], v[34:35]
    s_mov_b32 s69, 65536
PL_27:
    global_load_dwordx4 v[64:67], v10, s[34:35] sc1
    global_load_dwordx4 v[68:71], v11, s[34:35] sc1
    global_load_dwordx4 v[72:75], v12, s[34:35] sc1
    global_load_dwordx4 v[76:79], v13, s[34:35] sc1
PC_28:
    s_waitcnt vmcnt(3)
    v_max_u32 v8, v64, v65
    v_max3_u32 v8, v8, v66, v67
    s_waitcnt vmcnt(2)
    v_max3_u32 v8, v8, v68, v69
    v_max3_u32 v8, v8, v70, v71
    s_waitcnt vmcnt(1)
    v_max3_u32 v8, v8, v72, v73
    v_max3_u32 v8, v8, v74, v75
    s_waitcnt vmcnt(0)
    v_max3_u32 v8, v8, v76, v77
    v_max3_u32 v8, v8, v78, v79
    v_cmp_eq_u32 vcc, -1, v8
    s_cbranch_vccz PD_29
    s_sub_u32 s69, s69, 1
    s_cbranch_scc0 PL_27
PD_29:
    v_pk_add_f32 v[64:65], v[64:65], v[68:69]
    v_pk_add_f32 v[66:67], v[66:67], v[70:71]
    s_mov_b32 exec_hi, 0
    v_pk_add_f32 v[72:73], v[72:73], v[76:77]
    v_pk_add_f32 v[74:75], v[74:75], v[78:79]
    s_mov_b32 exec_hi, -1
    v_pk_add_f32 v[64:65], v[64:65], v[72:73]
    v_pk_add_f32 v[66:67], v[66:67], v[74:75]
    s_nop 0
    v_add_f32_dpp v64, v64, v64 row_ror:8 row_mask:0xf bank_mask:0xf
    v_add_f32_dpp v65, v65, v65 row_ror:8 row_mask:0xf bank_mask:0xf
    v_add_f32_dpp v66, v66, v66 row_ror:8 row_mask:0xf bank_mask:0xf
    v_add_f32_dpp v67, v67, v67 row_ror:8 row_mask:0xf bank_mask:0xf
    v_mov_b32 v68, v64
    v_mov_b32 v69, v65
    v_mov_b32 v70, v66
    v_mov_b32 v71, v67
    v_permlane16_swap_b32 v64, v68
    v_permlane16_swap_b32 v65, v69
    v_permlane16_swap_b32 v66, v70
    v_permlane16_swap_b32 v67, v71
    v_add_f32 v64, v64, v68
    v_add_f32 v65, v65, v69
    v_add_f32 v66, v66, v70
    v_add_f32 v67, v67, v71
    v_mov_b32 v68, v64
    v_mov_b32 v69, v65
    v_mov_b32 v70, v66
    v_mov_b32 v71, v67
    v_permlane32_swap_b32 v64, v68
    v_permlane32_swap_b32 v65, v69
    v_permlane32_swap_b32 v66, v70
    v_permlane32_swap_b32 v67, v71
    v_add_f32 v64, v64, v68
    v_add_f32 v65, v65, v69
    v_add_f32 v66, v66, v70
    v_add_f32 v67, v67, v71
    v_pk_fma_f32 v[32:33], v[64:65], v[16:17], v[32:33]
    v_pk_fma_f32 v[34:35], v[66:67], v[18:19], v[34:35]
    v_cvt_pk_bf16_f32 v32, v32, v33
    v_cvt_pk_bf16_f32 v33, v34, v35
    s_mov_b64 exec, 0xff
    global_store_dwordx2 v23, v[32:33], s[30:31]
    s_mov_b64 exec, -1
    s_branch FIN
ROLE_E:
    s_sub_u32 s40, s37, 7
    s_and_b32 s54, s40, 1
    s_lshr_b32 s40, s40, 1
    s_lshl_b32 s50, s36, 2
    s_add_u32 s50, s40, s50
    s_lshl_b32 s41, s38, 20
    s_lshl_b32 s42, s50, 8
    s_add_u32 s41, s41, s42
    s_lshl_b32 s43, s54, 7
    s_add_u32 s43, s43, s41
    v_lshlrev_b32 v5, 16, v3
    v_lshl_add_u32 v5, v6, 19, v5
    v_lshl_add_u32 v5, v7, 4, v5
    s_waitcnt lgkmcnt(0)
    s_add_u32 s44, s8, s43
    s_addc_u32 s45, s9, 0
    s_add_u32 s46, s44, 8192
    s_addc_u32 s47, s45, 0
    s_lshl_b32 s56, s50, 10
    s_lshl_b32 s49, s38, 8
    s_add_u32 s56, s56, s49
    s_mul_i32 s49, s54, 131072
    s_sub_u32 s56, s56, s49
    s_add_u32 s56, s56, 262144
    s_mul_i32 s49, 0, 384
    s_add_u32 s49, s49, 524160
    s_cmp_eq_u32 s38, 1
    s_cselect_b32 s49, s49, 0
    s_add_u32 s56, s56, s49
    s_cmp_eq_u32 s38, 1
    s_cselect_b32 s49, 384, 0
    s_add_u32 s49, s49, 32768
    v_lshrrev_b32 v8, 5, v0
    v_mul_u32_u24 v10, s49, v8
    v_add_u32 v10, s56, v10
    v_and_b32 v9, 31, v0
    v_lshl_add_u32 v8, v9, 3, v10
    global_store_dwordx2 v8, v[28:29], s[34:35] sc1
    v_lshl_add_u32 v10, v7, 4, v10
    s_lshl_b32 s51, s54, 5
    s_add_u32 s51, s51, s50
    s_lshl_b32 s52, s51, 10
    s_lshl_b32 s49, s38, 8
    s_add_u32 s52, s52, s49
    s_add_u32 s52, s52, 524288
    s_mul_i32 s49, s54, 384
    s_add_u32 s49, s49, 393088
    s_cmp_eq_u32 s38, 1
    s_cselect_b32 s49, s49, 0
    s_add_u32 s52, s52, s49
    v_add_u32 v8, s52, v1
    global_store_dword v8, v28, s[34:35] sc1
    s_load_dword s63, s[34:35], 261120
    global_load_dwordx4 v[64:67], v5, s[44:45]
    global_load_dwordx4 v[68:71], v5, s[46:47]
    v_add_u32 v5, 16384, v5
    global_load_dwordx4 v[72:75], v5, s[44:45]
    global_load_dwordx4 v[76:79], v5, s[46:47]
    v_add_u32 v5, 16384, v5
    global_load_dwordx4 v[80:83], v5, s[44:45]
    global_load_dwordx4 v[84:87], v5, s[46:47]
    v_add_u32 v5, 16384, v5
    global_load_dwordx4 v[88:91], v5, s[44:45]
    global_load_dwordx4 v[92:95], v5, s[46:47]
    v_add_u32 v5, 212992, v5
    global_load_dwordx4 v[96:99], v5, s[44:45]
    global_load_dwordx4 v[100:103], v5, s[46:47]
    v_add_u32 v5, 16384, v5
    global_load_dwordx4 v[104:107], v5, s[44:45]
    global_load_dwordx4 v[108:111], v5, s[46:47]
    v_add_u32 v5, 16384, v5
    global_load_dwordx4 v[112:115], v5, s[44:45]
    global_load_dwordx4 v[116:119], v5, s[46:47]
    v_add_u32 v5, 16384, v5
    global_load_dwordx4 v[120:123], v5, s[44:45]
    global_load_dwordx4 v[124:127], v5, s[46:47]
    s_add_u32 s46, s10, s43
    s_addc_u32 s47, s11, 0
    v_lshlrev_b32 v5, 13, v3
    v_lshl_add_u32 v5, v6, 15, v5
    v_lshl_add_u32 v5, v7, 4, v5
    s_lshl_b32 s57, s38, 14
    s_add_u32 s57, s57, 8192
    v_xor_b32 v8, 0, v5
    s_add_u32 m0, s57, 0
    s_nop 0
    global_load_lds_dwordx4 v8, s[46:47]
    v_xor_b32 v8, 65552, v5
    s_add_u32 m0, s57, 1024
    s_nop 0
    global_load_lds_dwordx4 v8, s[46:47]
    v_xor_b32 v8, 131104, v5
    s_add_u32 m0, s57, 2048
    s_nop 0
    global_load_lds_dwordx4 v8, s[46:47]
    v_xor_b32 v8, 196656, v5
    s_add_u32 m0, s57, 3072
    s_nop 0
    global_load_lds_dwordx4 v8, s[46:47]
    v_xor_b32 v8, 262208, v5
    s_add_u32 m0, s57, 4096
    s_nop 0
    global_load_lds_dwordx4 v8, s[46:47]
    v_xor_b32 v8, 327760, v5
    s_add_u32 m0, s57, 5120
    s_nop 0
    global_load_lds_dwordx4 v8, s[46:47]
    v_xor_b32 v8, 393312, v5
    s_add_u32 m0, s57, 6144
    s_nop 0
    global_load_lds_dwordx4 v8, s[46:47]
    v_xor_b32 v8, 458864, v5
    s_add_u32 m0, s57, 7168
    s_nop 0
    global_load_lds_dwordx4 v8, s[46:47]
    v_xor_b32 v8, 524288, v5
    s_add_u32 m0, s57, 8192
    s_nop 0
    global_load_lds_dwordx4 v8, s[46:47]
    v_xor_b32 v8, 589840, v5
    s_add_u32 m0, s57, 9216
    s_nop 0
    global_load_lds_dwordx4 v8, s[46:47]
    v_xor_b32 v8, 655392, v5
    s_add_u32 m0, s57, 10240
    s_nop 0
    global_load_lds_dwordx4 v8, s[46:47]
    v_xor_b32 v8, 720944, v5
    s_add_u32 m0, s57, 11264
    s_nop 0
    global_load_lds_dwordx4 v8, s[46:47]
    v_xor_b32 v8, 786496, v5
    s_add_u32 m0, s57, 12288
    s_nop 0
    global_load_lds_dwordx4 v8, s[46:47]
    v_xor_b32 v8, 852048, v5
    s_add_u32 m0, s57, 13312
    s_nop 0
    global_load_lds_dwordx4 v8, s[46:47]
    v_xor_b32 v8, 917600, v5
    s_add_u32 m0, s57, 14336
    s_nop 0
    global_load_lds_dwordx4 v8, s[46:47]
    v_xor_b32 v8, 983152, v5
    s_add_u32 m0, s57, 15360
    s_nop 0
    global_load_lds_dwordx4 v8, s[46:47]
    s_lshr_b32 s55, s51, 4
    s_lshl_b32 s53, s55, 12
    s_lshl_b32 s55, s55, 19
    s_and_b32 s49, s50, 15
    s_lshl_b32 s48, s49, 3
    s_add_u32 s53, s53, s48
    s_add_u32 s53, s53, 196608
    s_lshl_b32 s49, s49, 10
    s_add_u32 s55, s55, s49
    s_add_u32 s55, s55, 1048576
    s_mul_i32 s49, s54, -1048192
    s_add_u32 s49, s49, 2097024
    s_cmp_eq_u32 s38, 1
    s_cselect_b32 s49, s49, 0
    s_add_u32 s55, s55, s49
    s_lshl_b32 s49, s38, 12
    v_xor_b32 v9, v3, v7
    v_lshl_add_u32 v60, v9, 4, s57
    v_lshl_add_u32 v9, v9, 4, s49
    v_lshl_add_u32 v9, v6, 11, v9
    v_and_b32 v8, 3, v7
    v_lshl_add_u32 v9, v8, 9, v9
    v_lshrrev_b32 v8, 2, v7
    v_lshl_add_u32 v9, v8, 8, v9
    v_xor_b32 v11, 64, v9
    v_lshl_add_u32 v60, v7, 10, v60
    v_lshl_add_u32 v60, v6, 7, v60
    v_xor_b32 v61, 64, v60
    v_and_b32 v8, 1, v3
    v_lshl_add_u32 v8, v8, 2, s38
    v_xor_b32 v28, v8, v7
    v_lshlrev_b32 v28, 4, v28
    v_lshl_add_u32 v28, v8, 8, v28
    v_lshl_add_u32 v28, v6, 7, v28
    v_add_u32 v28, 131072, v28
    v_lshrrev_b32 v8, 1, v2
    v_xor_b32 v8, v8, v3
    v_lshlrev_b32 v29, 4, v8
    v_lshl_add_u32 v29, v2, 7, v29
    v_add_u32 v29, 131072, v29
    s_mov_b32 s64, 0x3e0293ee
    s_waitcnt lgkmcnt(0)
    s_mul_i32 s63, s63, 0x9e3779b1
    s_add_u32 s63, s63, 0x7f4a7c15
    s_waitcnt vmcnt(32)
    s_barrier
    s_lshl_b32 s68, s2, 7
    s_add_u32 s68, s68, 229376
    v_add_u32 v30, s68, v1
    v_mov_b32 v31, s63
    s_cmp_eq_u32 s38, 0
    s_cselect_b32 exec_lo, -1, 0
    s_mov_b32 exec_hi, 0
    global_store_dword v30, v31, s[34:35] sc1
    s_mov_b64 exec, -1
    s_waitcnt vmcnt(31)
    v_perm_b32 v128, v68, v64, s66
    v_perm_b32 v132, v68, v64, s67
    v_perm_b32 v136, v69, v65, s66
    v_perm_b32 v140, v69, v65, s67
    v_perm_b32 v144, v70, v66, s66
    v_perm_b32 v148, v70, v66, s67
    v_perm_b32 v152, v71, v67, s66
    v_perm_b32 v156, v71, v67, s67
    s_waitcnt vmcnt(29)
    v_perm_b32 v129, v76, v72, s66
    v_perm_b32 v133, v76, v72, s67
    v_perm_b32 v137, v77, v73, s66
    v_perm_b32 v141, v77, v73, s67
    v_perm_b32 v145, v78, v74, s66
    v_perm_b32 v149, v78, v74, s67
    v_perm_b32 v153, v79, v75, s66
    v_perm_b32 v157, v79, v75, s67
    s_waitcnt vmcnt(27)
    v_perm_b32 v130, v84, v80, s66
    v_perm_b32 v134, v84, v80, s67
    v_perm_b32 v138, v85, v81, s66
    v_perm_b32 v142, v85, v81, s67
    v_perm_b32 v146, v86, v82, s66
    v_perm_b32 v150, v86, v82, s67
    v_perm_b32 v154, v87, v83, s66
    v_perm_b32 v158, v87, v83, s67
    s_waitcnt vmcnt(25)
    v_perm_b32 v131, v92, v88, s66
    v_perm_b32 v135, v92, v88, s67
    v_perm_b32 v139, v93, v89, s66
    v_perm_b32 v143, v93, v89, s67
    v_perm_b32 v147, v94, v90, s66
    v_perm_b32 v151, v94, v90, s67
    v_perm_b32 v155, v95, v91, s66
    v_perm_b32 v159, v95, v91, s67
    global_load_dwordx4 v[12:15], v9, s[34:35] offset:0 sc1
    global_load_dwordx4 v[16:19], v9, s[34:35] offset:128 sc1
    global_load_dwordx4 v[20:23], v11, s[34:35] offset:0 sc1
    global_load_dwordx4 v[24:27], v11, s[34:35] offset:128 sc1
    s_waitcnt vmcnt(27)
    v_perm_b32 v160, v100, v96, s66
    v_perm_b32 v164, v100, v96, s67
    v_perm_b32 v168, v101, v97, s66
    v_perm_b32 v172, v101, v97, s67
    v_perm_b32 v176, v102, v98, s66
    v_perm_b32 v180, v102, v98, s67
    v_perm_b32 v184, v103, v99, s66
    v_perm_b32 v188, v103, v99, s67
    s_waitcnt vmcnt(25)
    v_perm_b32 v161, v108, v104, s66
    v_perm_b32 v165, v108, v104, s67
    v_perm_b32 v169, v109, v105, s66
    v_perm_b32 v173, v109, v105, s67
    v_perm_b32 v177, v110, v106, s66
    v_perm_b32 v181, v110, v106, s67
    v_perm_b32 v185, v111, v107, s66
    v_perm_b32 v189, v111, v107, s67
    s_waitcnt vmcnt(23)
    v_perm_b32 v162, v116, v112, s66
    v_perm_b32 v166, v116, v112, s67
    v_perm_b32 v170, v117, v113, s66
    v_perm_b32 v174, v117, v113, s67
    v_perm_b32 v178, v118, v114, s66
    v_perm_b32 v182, v118, v114, s67
    v_perm_b32 v186, v119, v115, s66
    v_perm_b32 v190, v119, v115, s67
    s_waitcnt vmcnt(21)
    v_perm_b32 v163, v124, v120, s66
    v_perm_b32 v167, v124, v120, s67
    v_perm_b32 v171, v125, v121, s66
    v_perm_b32 v175, v125, v121, s67
    v_perm_b32 v179, v126, v122, s66
    v_perm_b32 v183, v126, v122, s67
    v_perm_b32 v187, v127, v123, s66
    v_perm_b32 v191, v127, v123, s67
    s_add_u32 s44, s12, s41
    s_addc_u32 s45, s13, 0
    v_lshlrev_b32 v5, 13, v3
    v_lshl_add_u32 v5, v2, 4, v5
    s_lshl_b32 s41, s50, 17
    s_lshl_b32 s49, s38, 8
    s_add_u32 s41, s41, s49
    s_add_u32 s46, s14, s41
    s_addc_u32 s47, s15, 0
    s_and_b32 s62, s54, 1
    s_waitcnt vmcnt(13)
    ds_read_b128 v[192:195], v60 offset:0
    ds_read_b128 v[196:199], v61 offset:0
    ds_read_b128 v[200:203], v60 offset:256
    ds_read_b128 v[204:207], v61 offset:256
    ds_read_b128 v[208:211], v60 offset:512
    ds_read_b128 v[212:215], v61 offset:512
    ds_read_b128 v[216:219], v60 offset:768
    ds_read_b128 v[220:223], v61 offset:768
    s_waitcnt vmcnt(5)
    ds_read_b128 v[224:227], v60 offset:8192
    ds_read_b128 v[228:231], v61 offset:8192
    ds_read_b128 v[232:235], v60 offset:8448
    ds_read_b128 v[236:239], v61 offset:8448
    ds_read_b128 v[240:243], v60 offset:8704
    ds_read_b128 v[244:247], v61 offset:8704
    ds_read_b128 v[248:251], v60 offset:8960
    ds_read_b128 v[252:255], v61 offset:8960
    s_mov_b32 s69, 65536
    s_branch HC_31
HL_30:
    global_load_dwordx4 v[12:15], v9, s[34:35] offset:0 sc1
    global_load_dwordx4 v[16:19], v9, s[34:35] offset:128 sc1
    global_load_dwordx4 v[20:23], v11, s[34:35] offset:0 sc1
    global_load_dwordx4 v[24:27], v11, s[34:35] offset:128 sc1
HC_31:
    s_waitcnt vmcnt(3)
    v_xor_b32 v12, s63, v12
    s_waitcnt vmcnt(2)
    v_xor_b32 v19, s63, v19
    s_waitcnt vmcnt(1)
    v_xor_b32 v20, s63, v20
    v_or3_b32 v12, v12, v19, v20
    s_waitcnt vmcnt(0)
    v_xor_b32 v27, s63, v27
    v_or_b32 v12, v12, v27
    v_cmp_ne_u32 vcc, 0, v12
    s_cbranch_vccz HD_32
    s_sub_u32 s69, s69, 1
    s_cbranch_scc0 HL_30
HD_32:
    v_mfma_f32_16x16x32_bf16 v[32:35], v[14:17], v[128:131], 0
    v_mfma_f32_16x16x32_bf16 v[36:39], v[14:17], v[132:135], 0
    v_mfma_f32_16x16x32_bf16 v[40:43], v[14:17], v[136:139], 0
    v_mfma_f32_16x16x32_bf16 v[44:47], v[14:17], v[140:143], 0
    v_mfma_f32_16x16x32_bf16 v[48:51], v[14:17], v[144:147], 0
    v_mfma_f32_16x16x32_bf16 v[52:55], v[14:17], v[148:151], 0
    v_mfma_f32_16x16x32_bf16 v[56:59], v[14:17], v[152:155], 0
    v_mfma_f32_16x16x32_bf16 v[60:63], v[14:17], v[156:159], 0
    v_mfma_f32_16x16x32_bf16 v[32:35], v[22:25], v[160:163], v[32:35]
    v_mfma_f32_16x16x32_bf16 v[36:39], v[22:25], v[164:167], v[36:39]
    v_mfma_f32_16x16x32_bf16 v[40:43], v[22:25], v[168:171], v[40:43]
    v_mfma_f32_16x16x32_bf16 v[44:47], v[22:25], v[172:175], v[44:47]
    v_mfma_f32_16x16x32_bf16 v[48:51], v[22:25], v[176:179], v[48:51]
    v_mfma_f32_16x16x32_bf16 v[52:55], v[22:25], v[180:183], v[52:55]
    v_mfma_f32_16x16x32_bf16 v[56:59], v[22:25], v[184:187], v[56:59]
    v_mfma_f32_16x16x32_bf16 v[60:63], v[22:25], v[188:191], v[60:63]
    s_nop 0
    v_pk_add_f32 v[32:33], v[32:33], v[34:35]
    v_add_f32 v32, v32, v33
    v_pk_add_f32 v[36:37], v[36:37], v[38:39]
    v_add_f32 v36, v36, v37
    v_pk_add_f32 v[40:41], v[40:41], v[42:43]
    v_add_f32 v40, v40, v41
    v_pk_add_f32 v[44:45], v[44:45], v[46:47]
    v_add_f32 v44, v44, v45
    v_pk_add_f32 v[48:49], v[48:49], v[50:51]
    v_add_f32 v48, v48, v49
    v_pk_add_f32 v[52:53], v[52:53], v[54:55]
    v_add_f32 v52, v52, v53
    v_pk_add_f32 v[56:57], v[56:57], v[58:59]
    v_add_f32 v56, v56, v57
    v_pk_add_f32 v[60:61], v[60:61], v[62:63]
    v_add_f32 v60, v60, v61
    v_cvt_pk_bf16_f32 v12, v32, v36
    v_cvt_pk_bf16_f32 v13, v40, v44
    v_cvt_pk_bf16_f32 v14, v48, v52
    v_cvt_pk_bf16_f32 v15, v56, v60
    s_mov_b32 exec_lo, 0x00ff00ff
    s_mov_b32 exec_hi, 0xff00ff00
    ds_write_b128 v28, v[12:15]
    s_mov_b64 exec, -1
    v_xor_b32 v28, 64, v29
    s_waitcnt lgkmcnt(0)
    s_barrier
    ds_read_b128 v[16:19], v29
    ds_read_b128 v[20:23], v28
    s_waitcnt lgkmcnt(1)
    v_mfma_f32_16x16x32_bf16 v[32:35], v[16:19], v[192:195], 0
    v_mfma_f32_16x16x32_bf16 v[36:39], v[16:19], v[200:203], 0
    v_mfma_f32_16x16x32_bf16 v[40:43], v[16:19], v[208:211], 0
    v_mfma_f32_16x16x32_bf16 v[44:47], v[16:19], v[216:219], 0
    s_waitcnt lgkmcnt(0)
    v_mfma_f32_16x16x32_bf16 v[32:35], v[20:23], v[196:199], v[32:35]
    v_mfma_f32_16x16x32_bf16 v[36:39], v[20:23], v[204:207], v[36:39]
    v_mfma_f32_16x16x32_bf16 v[40:43], v[20:23], v[212:215], v[40:43]
    v_mfma_f32_16x16x32_bf16 v[44:47], v[20:23], v[220:223], v[44:47]
    v_mfma_f32_16x16x32_bf16 v[48:51], v[16:19], v[224:227], 0
    v_mfma_f32_16x16x32_bf16 v[52:55], v[16:19], v[232:235], 0
    v_mfma_f32_16x16x32_bf16 v[56:59], v[16:19], v[240:243], 0
    v_mfma_f32_16x16x32_bf16 v[60:63], v[16:19], v[248:251], 0
    v_mfma_f32_16x16x32_bf16 v[48:51], v[20:23], v[228:231], v[48:51]
    v_mfma_f32_16x16x32_bf16 v[52:55], v[20:23], v[236:239], v[52:55]
    v_mfma_f32_16x16x32_bf16 v[56:59], v[20:23], v[244:247], v[56:59]
    v_mfma_f32_16x16x32_bf16 v[60:63], v[20:23], v[252:255], v[60:63]
    v_pk_add_f32 v[32:33], v[32:33], v[34:35]
    v_pk_add_f32 v[36:37], v[36:37], v[38:39]
    v_pk_add_f32 v[40:41], v[40:41], v[42:43]
    v_pk_add_f32 v[44:45], v[44:45], v[46:47]
    v_add_f32 v32, v32, v33
    v_add_f32 v36, v36, v37
    v_add_f32 v40, v40, v41
    v_add_f32 v44, v44, v45
    v_mov_b32 v33, v32
    v_mov_b32 v37, v36
    v_mov_b32 v41, v40
    v_mov_b32 v45, v44
    v_permlane16_swap_b32 v32, v33
    v_permlane16_swap_b32 v36, v37
    v_permlane16_swap_b32 v40, v41
    v_permlane16_swap_b32 v44, v45
    v_add_f32 v32, v32, v33
    v_add_f32 v36, v36, v37
    v_add_f32 v40, v40, v41
    v_add_f32 v44, v44, v45
    v_mul_f32 v32, s64, v32
    v_mul_f32 v36, s64, v36
    v_mul_f32 v40, s64, v40
    v_mul_f32 v44, s64, v44
    v_cvt_pk_bf16_f32 v12, v32, v36
    v_cvt_pk_bf16_f32 v13, v40, v44
    s_nop 0
    v_mov_b32_dpp v14, v12 row_ror:8 row_mask:0xf bank_mask:0xf
    v_mov_b32_dpp v15, v13 row_ror:8 row_mask:0xf bank_mask:0xf
    s_mov_b32 exec_lo, 0xff
    s_mov_b32 exec_hi, 0xff
    global_store_dwordx4 v10, v[12:15], s[34:35] offset:0 sc1
    s_mov_b64 exec, -1
    v_pk_add_f32 v[48:49], v[48:49], v[50:51]
    v_pk_add_f32 v[52:53], v[52:53], v[54:55]
    v_pk_add_f32 v[56:57], v[56:57], v[58:59]
    v_pk_add_f32 v[60:61], v[60:61], v[62:63]
    v_add_f32 v48, v48, v49
    v_add_f32 v52, v52, v53
    v_add_f32 v56, v56, v57
    v_add_f32 v60, v60, v61
    v_mov_b32 v49, v48
    v_mov_b32 v53, v52
    v_mov_b32 v57, v56
    v_mov_b32 v61, v60
    v_permlane16_swap_b32 v48, v49
    v_permlane16_swap_b32 v52, v53
    v_permlane16_swap_b32 v56, v57
    v_permlane16_swap_b32 v60, v61
    v_add_f32 v48, v48, v49
    v_add_f32 v52, v52, v53
    v_add_f32 v56, v56, v57
    v_add_f32 v60, v60, v61
    v_mul_f32 v48, s64, v48
    v_mul_f32 v52, s64, v52
    v_mul_f32 v56, s64, v56
    v_mul_f32 v60, s64, v60
    v_cvt_pk_bf16_f32 v16, v48, v52
    v_cvt_pk_bf16_f32 v17, v56, v60
    s_nop 0
    v_mov_b32_dpp v18, v16 row_ror:8 row_mask:0xf bank_mask:0xf
    v_mov_b32_dpp v19, v17 row_ror:8 row_mask:0xf bank_mask:0xf
    s_mov_b32 exec_lo, 0xff
    s_mov_b32 exec_hi, 0xff
    global_store_dwordx4 v10, v[16:19], s[34:35] offset:128 sc1
    s_mov_b64 exec, -1
    v_add_u32 v30, -163840, v30
    s_cmp_eq_u32 s38, 3
    s_cselect_b32 exec_lo, -1, 0
    s_mov_b32 exec_hi, 0
    global_store_dword v30, v31, s[34:35] sc1
    s_mov_b64 exec, -1
    s_barrier
    s_cmp_eq_u32 s62, 0
    s_cselect_b64 s[60:61], s[44:45], s[46:47]
    s_cselect_b32 s56, 131072, 0
    s_cselect_b32 s57, -327680, 0
    s_cselect_b32 s58, -425984, 0
    s_cselect_b32 s59, 32768, 0
    s_cselect_b32 s48, 0, 1024
    s_cselect_b32 s49, 0, 25600
    s_or_b32 s56, s56, s48
    s_or_b32 s57, s57, s48
    s_or_b32 s58, s58, s49
    s_or_b32 s59, s59, s49
    v_mov_b32 v8, v5
    global_load_dwordx4 v[64:67], v8, s[60:61]
    v_add_u32 v8, s56, v8
    global_load_dwordx4 v[68:71], v8, s[60:61]
    v_add_u32 v8, s56, v8
    global_load_dwordx4 v[72:75], v8, s[60:61]
    v_add_u32 v8, s56, v8
    global_load_dwordx4 v[76:79], v8, s[60:61]
    v_add_u32 v8, s57, v8
    global_load_dwordx4 v[80:83], v8, s[60:61]
    v_add_u32 v8, s56, v8
    global_load_dwordx4 v[84:87], v8, s[60:61]
    v_add_u32 v8, s56, v8
    global_load_dwordx4 v[88:91], v8, s[60:61]
    v_add_u32 v8, s56, v8
    global_load_dwordx4 v[92:95], v8, s[60:61]
    v_add_u32 v8, s58, v8
    global_load_dwordx4 v[96:99], v8, s[60:61]
    v_add_u32 v8, s56, v8
    global_load_dwordx4 v[100:103], v8, s[60:61]
    v_add_u32 v8, s56, v8
    global_load_dwordx4 v[104:107], v8, s[60:61]
    v_add_u32 v8, s56, v8
    global_load_dwordx4 v[108:111], v8, s[60:61]
    v_add_u32 v8, s57, v8
    global_load_dwordx4 v[112:115], v8, s[60:61]
    v_add_u32 v8, s56, v8
    global_load_dwordx4 v[116:119], v8, s[60:61]
    v_add_u32 v8, s56, v8
    global_load_dwordx4 v[120:123], v8, s[60:61]
    v_add_u32 v8, s56, v8
    global_load_dwordx4 v[124:127], v8, s[60:61]
    v_add_u32 v8, s59, v8
    global_load_dwordx4 v[32:35], v8, s[60:61]
    v_add_u32 v8, s56, v8
    global_load_dwordx4 v[36:39], v8, s[60:61]
    v_add_u32 v8, s56, v8
    global_load_dwordx4 v[40:43], v8, s[60:61]
    v_add_u32 v8, s56, v8
    global_load_dwordx4 v[44:47], v8, s[60:61]
    v_add_u32 v8, s57, v8
    global_load_dwordx4 v[48:51], v8, s[60:61]
    v_add_u32 v8, s56, v8
    global_load_dwordx4 v[52:55], v8, s[60:61]
    v_add_u32 v8, s56, v8
    global_load_dwordx4 v[56:59], v8, s[60:61]
    v_add_u32 v8, s56, v8
    global_load_dwordx4 v[60:63], v8, s[60:61]
    v_add_u32 v8, s58, v8
    s_waitcnt vmcnt(22)
    v_perm_b32 v22, v68, v64, s66
    v_accvgpr_write_b32 a0, v22
    v_perm_b32 v23, v68, v64, s67
    v_accvgpr_write_b32 a4, v23
    v_perm_b32 v22, v69, v65, s66
    v_accvgpr_write_b32 a8, v22
    v_perm_b32 v23, v69, v65, s67
    v_accvgpr_write_b32 a12, v23
    v_perm_b32 v22, v70, v66, s66
    v_accvgpr_write_b32 a16, v22
    v_perm_b32 v23, v70, v66, s67
    v_accvgpr_write_b32 a20, v23
    v_perm_b32 v22, v71, v67, s66
    v_accvgpr_write_b32 a24, v22
    v_perm_b32 v23, v71, v67, s67
    v_accvgpr_write_b32 a28, v23
    s_waitcnt vmcnt(20)
    v_perm_b32 v22, v76, v72, s66
    v_accvgpr_write_b32 a1, v22
    v_perm_b32 v23, v76, v72, s67
    v_accvgpr_write_b32 a5, v23
    v_perm_b32 v22, v77, v73, s66
    v_accvgpr_write_b32 a9, v22
    v_perm_b32 v23, v77, v73, s67
    v_accvgpr_write_b32 a13, v23
    v_perm_b32 v22, v78, v74, s66
    v_accvgpr_write_b32 a17, v22
    v_perm_b32 v23, v78, v74, s67
    v_accvgpr_write_b32 a21, v23
    v_perm_b32 v22, v79, v75, s66
    v_accvgpr_write_b32 a25, v22
    v_perm_b32 v23, v79, v75, s67
    v_accvgpr_write_b32 a29, v23
    s_waitcnt vmcnt(18)
    v_perm_b32 v22, v84, v80, s66
    v_accvgpr_write_b32 a2, v22
    v_perm_b32 v23, v84, v80, s67
    v_accvgpr_write_b32 a6, v23
    v_perm_b32 v22, v85, v81, s66
    v_accvgpr_write_b32 a10, v22
    v_perm_b32 v23, v85, v81, s67
    v_accvgpr_write_b32 a14, v23
    v_perm_b32 v22, v86, v82, s66
    v_accvgpr_write_b32 a18, v22
    v_perm_b32 v23, v86, v82, s67
    v_accvgpr_write_b32 a22, v23
    v_perm_b32 v22, v87, v83, s66
    v_accvgpr_write_b32 a26, v22
    v_perm_b32 v23, v87, v83, s67
    v_accvgpr_write_b32 a30, v23
    s_waitcnt vmcnt(16)
    v_perm_b32 v22, v92, v88, s66
    v_accvgpr_write_b32 a3, v22
    v_perm_b32 v23, v92, v88, s67
    v_accvgpr_write_b32 a7, v23
    v_perm_b32 v22, v93, v89, s66
    v_accvgpr_write_b32 a11, v22
    v_perm_b32 v23, v93, v89, s67
    v_accvgpr_write_b32 a15, v23
    v_perm_b32 v22, v94, v90, s66
    v_accvgpr_write_b32 a19, v22
    v_perm_b32 v23, v94, v90, s67
    v_accvgpr_write_b32 a23, v23
    v_perm_b32 v22, v95, v91, s66
    v_accvgpr_write_b32 a27, v22
    v_perm_b32 v23, v95, v91, s67
    v_accvgpr_write_b32 a31, v23
    global_load_dwordx4 v[64:67], v8, s[60:61]
    v_add_u32 v8, s56, v8
    global_load_dwordx4 v[68:71], v8, s[60:61]
    v_add_u32 v8, s56, v8
    global_load_dwordx4 v[72:75], v8, s[60:61]
    v_add_u32 v8, s56, v8
    global_load_dwordx4 v[76:79], v8, s[60:61]
    v_add_u32 v8, s57, v8
    global_load_dwordx4 v[80:83], v8, s[60:61]
    v_add_u32 v8, s56, v8
    global_load_dwordx4 v[84:87], v8, s[60:61]
    v_add_u32 v8, s56, v8
    global_load_dwordx4 v[88:91], v8, s[60:61]
    v_add_u32 v8, s56, v8
    global_load_dwordx4 v[92:95], v8, s[60:61]
    s_waitcnt vmcnt(22)
    v_perm_b32 v22, v100, v96, s66
    v_accvgpr_write_b32 a32, v22
    v_perm_b32 v23, v100, v96, s67
    v_accvgpr_write_b32 a36, v23
    v_perm_b32 v22, v101, v97, s66
    v_accvgpr_write_b32 a40, v22
    v_perm_b32 v23, v101, v97, s67
    v_accvgpr_write_b32 a44, v23
    v_perm_b32 v22, v102, v98, s66
    v_accvgpr_write_b32 a48, v22
    v_perm_b32 v23, v102, v98, s67
    v_accvgpr_write_b32 a52, v23
    v_perm_b32 v22, v103, v99, s66
    v_accvgpr_write_b32 a56, v22
    v_perm_b32 v23, v103, v99, s67
    v_accvgpr_write_b32 a60, v23
    s_waitcnt vmcnt(20)
    v_perm_b32 v22, v108, v104, s66
    v_accvgpr_write_b32 a33, v22
    v_perm_b32 v23, v108, v104, s67
    v_accvgpr_write_b32 a37, v23
    v_perm_b32 v22, v109, v105, s66
    v_accvgpr_write_b32 a41, v22
    v_perm_b32 v23, v109, v105, s67
    v_accvgpr_write_b32 a45, v23
    v_perm_b32 v22, v110, v106, s66
    v_accvgpr_write_b32 a49, v22
    v_perm_b32 v23, v110, v106, s67
    v_accvgpr_write_b32 a53, v23
    v_perm_b32 v22, v111, v107, s66
    v_accvgpr_write_b32 a57, v22
    v_perm_b32 v23, v111, v107, s67
    v_accvgpr_write_b32 a61, v23
    s_waitcnt vmcnt(18)
    v_perm_b32 v22, v116, v112, s66
    v_accvgpr_write_b32 a34, v22
    v_perm_b32 v23, v116, v112, s67
    v_accvgpr_write_b32 a38, v23
    v_perm_b32 v22, v117, v113, s66
    v_accvgpr_write_b32 a42, v22
    v_perm_b32 v23, v117, v113, s67
    v_accvgpr_write_b32 a46, v23
    v_perm_b32 v22, v118, v114, s66
    v_accvgpr_write_b32 a50, v22
    v_perm_b32 v23, v118, v114, s67
    v_accvgpr_write_b32 a54, v23
    v_perm_b32 v22, v119, v115, s66
    v_accvgpr_write_b32 a58, v22
    v_perm_b32 v23, v119, v115, s67
    v_accvgpr_write_b32 a62, v23
    s_waitcnt vmcnt(16)
    v_perm_b32 v22, v124, v120, s66
    v_accvgpr_write_b32 a35, v22
    v_perm_b32 v23, v124, v120, s67
    v_accvgpr_write_b32 a39, v23
    v_perm_b32 v22, v125, v121, s66
    v_accvgpr_write_b32 a43, v22
    v_perm_b32 v23, v125, v121, s67
    v_accvgpr_write_b32 a47, v23
    v_perm_b32 v22, v126, v122, s66
    v_accvgpr_write_b32 a51, v22
    v_perm_b32 v23, v126, v122, s67
    v_accvgpr_write_b32 a55, v23
    v_perm_b32 v22, v127, v123, s66
    v_accvgpr_write_b32 a59, v22
    v_perm_b32 v23, v127, v123, s67
    v_accvgpr_write_b32 a63, v23
    s_cmp_eq_u32 s62, 1
    s_cselect_b64 s[60:61], s[44:45], s[46:47]
    s_cselect_b32 s56, 131072, 0
    s_cselect_b32 s57, -327680, 0
    s_cselect_b32 s58, -425984, 0
    s_cselect_b32 s59, 32768, 0
    s_cselect_b32 s48, 0, 1024
    s_cselect_b32 s49, 0, 25600
    s_or_b32 s56, s56, s48
    s_or_b32 s57, s57, s48
    s_or_b32 s58, s58, s49
    s_or_b32 s59, s59, s49
    v_mov_b32 v8, v5
    global_load_dwordx4 v[96:99], v8, s[60:61]
    v_add_u32 v8, s56, v8
    global_load_dwordx4 v[100:103], v8, s[60:61]
    v_add_u32 v8, s56, v8
    global_load_dwordx4 v[104:107], v8, s[60:61]
    v_add_u32 v8, s56, v8
    global_load_dwordx4 v[108:111], v8, s[60:61]
    v_add_u32 v8, s57, v8
    global_load_dwordx4 v[112:115], v8, s[60:61]
    v_add_u32 v8, s56, v8
    global_load_dwordx4 v[116:119], v8, s[60:61]
    v_add_u32 v8, s56, v8
    global_load_dwordx4 v[120:123], v8, s[60:61]
    v_add_u32 v8, s56, v8
    global_load_dwordx4 v[124:127], v8, s[60:61]
    v_add_u32 v8, s58, v8
    s_waitcnt vmcnt(22)
    v_perm_b32 v22, v36, v32, s66
    v_accvgpr_write_b32 a64, v22
    v_perm_b32 v23, v36, v32, s67
    v_accvgpr_write_b32 a68, v23
    v_perm_b32 v22, v37, v33, s66
    v_accvgpr_write_b32 a72, v22
    v_perm_b32 v23, v37, v33, s67
    v_accvgpr_write_b32 a76, v23
    v_perm_b32 v22, v38, v34, s66
    v_accvgpr_write_b32 a80, v22
    v_perm_b32 v23, v38, v34, s67
    v_accvgpr_write_b32 a84, v23
    v_perm_b32 v22, v39, v35, s66
    v_accvgpr_write_b32 a88, v22
    v_perm_b32 v23, v39, v35, s67
    v_accvgpr_write_b32 a92, v23
    s_waitcnt vmcnt(20)
    v_perm_b32 v22, v44, v40, s66
    v_accvgpr_write_b32 a65, v22
    v_perm_b32 v23, v44, v40, s67
    v_accvgpr_write_b32 a69, v23
    v_perm_b32 v22, v45, v41, s66
    v_accvgpr_write_b32 a73, v22
    v_perm_b32 v23, v45, v41, s67
    v_accvgpr_write_b32 a77, v23
    v_perm_b32 v22, v46, v42, s66
    v_accvgpr_write_b32 a81, v22
    v_perm_b32 v23, v46, v42, s67
    v_accvgpr_write_b32 a85, v23
    v_perm_b32 v22, v47, v43, s66
    v_accvgpr_write_b32 a89, v22
    v_perm_b32 v23, v47, v43, s67
    v_accvgpr_write_b32 a93, v23
    s_waitcnt vmcnt(18)
    v_perm_b32 v22, v52, v48, s66
    v_accvgpr_write_b32 a66, v22
    v_perm_b32 v23, v52, v48, s67
    v_accvgpr_write_b32 a70, v23
    v_perm_b32 v22, v53, v49, s66
    v_accvgpr_write_b32 a74, v22
    v_perm_b32 v23, v53, v49, s67
    v_accvgpr_write_b32 a78, v23
    v_perm_b32 v22, v54, v50, s66
    v_accvgpr_write_b32 a82, v22
    v_perm_b32 v23, v54, v50, s67
    v_accvgpr_write_b32 a86, v23
    v_perm_b32 v22, v55, v51, s66
    v_accvgpr_write_b32 a90, v22
    v_perm_b32 v23, v55, v51, s67
    v_accvgpr_write_b32 a94, v23
    s_waitcnt vmcnt(16)
    v_perm_b32 v22, v60, v56, s66
    v_accvgpr_write_b32 a67, v22
    v_perm_b32 v23, v60, v56, s67
    v_accvgpr_write_b32 a71, v23
    v_perm_b32 v22, v61, v57, s66
    v_accvgpr_write_b32 a75, v22
    v_perm_b32 v23, v61, v57, s67
    v_accvgpr_write_b32 a79, v23
    v_perm_b32 v22, v62, v58, s66
    v_accvgpr_write_b32 a83, v22
    v_perm_b32 v23, v62, v58, s67
    v_accvgpr_write_b32 a87, v23
    v_perm_b32 v22, v63, v59, s66
    v_accvgpr_write_b32 a91, v22
    v_perm_b32 v23, v63, v59, s67
    v_accvgpr_write_b32 a95, v23
    global_load_dwordx4 v[32:35], v8, s[60:61]
    v_add_u32 v8, s56, v8
    global_load_dwordx4 v[36:39], v8, s[60:61]
    v_add_u32 v8, s56, v8
    global_load_dwordx4 v[40:43], v8, s[60:61]
    v_add_u32 v8, s56, v8
    global_load_dwordx4 v[44:47], v8, s[60:61]
    v_add_u32 v8, s57, v8
    global_load_dwordx4 v[48:51], v8, s[60:61]
    v_add_u32 v8, s56, v8
    global_load_dwordx4 v[52:55], v8, s[60:61]
    v_add_u32 v8, s56, v8
    global_load_dwordx4 v[56:59], v8, s[60:61]
    v_add_u32 v8, s56, v8
    global_load_dwordx4 v[60:63], v8, s[60:61]
    v_add_u32 v8, s59, v8
    s_waitcnt vmcnt(22)
    v_perm_b32 v22, v68, v64, s66
    v_accvgpr_write_b32 a96, v22
    v_perm_b32 v23, v68, v64, s67
    v_accvgpr_write_b32 a100, v23
    v_perm_b32 v22, v69, v65, s66
    v_accvgpr_write_b32 a104, v22
    v_perm_b32 v23, v69, v65, s67
    v_accvgpr_write_b32 a108, v23
    v_perm_b32 v22, v70, v66, s66
    v_accvgpr_write_b32 a112, v22
    v_perm_b32 v23, v70, v66, s67
    v_accvgpr_write_b32 a116, v23
    v_perm_b32 v22, v71, v67, s66
    v_accvgpr_write_b32 a120, v22
    v_perm_b32 v23, v71, v67, s67
    v_accvgpr_write_b32 a124, v23
    s_waitcnt vmcnt(20)
    v_perm_b32 v22, v76, v72, s66
    v_accvgpr_write_b32 a97, v22
    v_perm_b32 v23, v76, v72, s67
    v_accvgpr_write_b32 a101, v23
    v_perm_b32 v22, v77, v73, s66
    v_accvgpr_write_b32 a105, v22
    v_perm_b32 v23, v77, v73, s67
    v_accvgpr_write_b32 a109, v23
    v_perm_b32 v22, v78, v74, s66
    v_accvgpr_write_b32 a113, v22
    v_perm_b32 v23, v78, v74, s67
    v_accvgpr_write_b32 a117, v23
    v_perm_b32 v22, v79, v75, s66
    v_accvgpr_write_b32 a121, v22
    v_perm_b32 v23, v79, v75, s67
    v_accvgpr_write_b32 a125, v23
    s_waitcnt vmcnt(18)
    v_perm_b32 v22, v84, v80, s66
    v_accvgpr_write_b32 a98, v22
    v_perm_b32 v23, v84, v80, s67
    v_accvgpr_write_b32 a102, v23
    v_perm_b32 v22, v85, v81, s66
    v_accvgpr_write_b32 a106, v22
    v_perm_b32 v23, v85, v81, s67
    v_accvgpr_write_b32 a110, v23
    v_perm_b32 v22, v86, v82, s66
    v_accvgpr_write_b32 a114, v22
    v_perm_b32 v23, v86, v82, s67
    v_accvgpr_write_b32 a118, v23
    v_perm_b32 v22, v87, v83, s66
    v_accvgpr_write_b32 a122, v22
    v_perm_b32 v23, v87, v83, s67
    v_accvgpr_write_b32 a126, v23
    s_waitcnt vmcnt(16)
    v_perm_b32 v22, v92, v88, s66
    v_accvgpr_write_b32 a99, v22
    v_perm_b32 v23, v92, v88, s67
    v_accvgpr_write_b32 a103, v23
    v_perm_b32 v22, v93, v89, s66
    v_accvgpr_write_b32 a107, v22
    v_perm_b32 v23, v93, v89, s67
    v_accvgpr_write_b32 a111, v23
    v_perm_b32 v22, v94, v90, s66
    v_accvgpr_write_b32 a115, v22
    v_perm_b32 v23, v94, v90, s67
    v_accvgpr_write_b32 a119, v23
    v_perm_b32 v22, v95, v91, s66
    v_accvgpr_write_b32 a123, v22
    v_perm_b32 v23, v95, v91, s67
    v_accvgpr_write_b32 a127, v23
    global_load_dwordx4 v[64:67], v8, s[60:61]
    v_add_u32 v8, s56, v8
    global_load_dwordx4 v[68:71], v8, s[60:61]
    v_add_u32 v8, s56, v8
    global_load_dwordx4 v[72:75], v8, s[60:61]
    v_add_u32 v8, s56, v8
    global_load_dwordx4 v[76:79], v8, s[60:61]
    v_add_u32 v8, s57, v8
    global_load_dwordx4 v[80:83], v8, s[60:61]
    v_add_u32 v8, s56, v8
    global_load_dwordx4 v[84:87], v8, s[60:61]
    v_add_u32 v8, s56, v8
    global_load_dwordx4 v[88:91], v8, s[60:61]
    v_add_u32 v8, s56, v8
    global_load_dwordx4 v[92:95], v8, s[60:61]
    v_add_u32 v8, s58, v8
    s_waitcnt vmcnt(22)
    v_perm_b32 v128, v100, v96, s66
    v_perm_b32 v132, v100, v96, s67
    v_perm_b32 v136, v101, v97, s66
    v_perm_b32 v140, v101, v97, s67
    v_perm_b32 v144, v102, v98, s66
    v_perm_b32 v148, v102, v98, s67
    v_perm_b32 v152, v103, v99, s66
    v_perm_b32 v156, v103, v99, s67
    s_waitcnt vmcnt(20)
    v_perm_b32 v129, v108, v104, s66
    v_perm_b32 v133, v108, v104, s67
    v_perm_b32 v137, v109, v105, s66
    v_perm_b32 v141, v109, v105, s67
    v_perm_b32 v145, v110, v106, s66
    v_perm_b32 v149, v110, v106, s67
    v_perm_b32 v153, v111, v107, s66
    v_perm_b32 v157, v111, v107, s67
    s_waitcnt vmcnt(18)
    v_perm_b32 v130, v116, v112, s66
    v_perm_b32 v134, v116, v112, s67
    v_perm_b32 v138, v117, v113, s66
    v_perm_b32 v142, v117, v113, s67
    v_perm_b32 v146, v118, v114, s66
    v_perm_b32 v150, v118, v114, s67
    v_perm_b32 v154, v119, v115, s66
    v_perm_b32 v158, v119, v115, s67
    s_waitcnt vmcnt(16)
    v_perm_b32 v131, v124, v120, s66
    v_perm_b32 v135, v124, v120, s67
    v_perm_b32 v139, v125, v121, s66
    v_perm_b32 v143, v125, v121, s67
    v_perm_b32 v147, v126, v122, s66
    v_perm_b32 v151, v126, v122, s67
    v_perm_b32 v155, v127, v123, s66
    v_perm_b32 v159, v127, v123, s67
    global_load_dwordx4 v[96:99], v8, s[60:61]
    v_add_u32 v8, s56, v8
    global_load_dwordx4 v[100:103], v8, s[60:61]
    v_add_u32 v8, s56, v8
    global_load_dwordx4 v[104:107], v8, s[60:61]
    v_add_u32 v8, s56, v8
    global_load_dwordx4 v[108:111], v8, s[60:61]
    v_add_u32 v8, s57, v8
    global_load_dwordx4 v[112:115], v8, s[60:61]
    v_add_u32 v8, s56, v8
    global_load_dwordx4 v[116:119], v8, s[60:61]
    v_add_u32 v8, s56, v8
    global_load_dwordx4 v[120:123], v8, s[60:61]
    v_add_u32 v8, s56, v8
    global_load_dwordx4 v[124:127], v8, s[60:61]
    s_lshl_b32 s49, s54, 3
    s_lshr_b32 s48, s50, 4
    s_add_u32 s49, s49, s48
    s_lshl_b32 s49, s49, 10
    s_add_u32 s49, s49, 244736
    v_bfe_u32 v30, v0, 3, 2
    v_lshl_add_u32 v30, v30, 11, s49
    v_lshl_add_u32 v30, v7, 7, v30
    global_load_dword v31, v30, s[34:35] sc1
    s_waitcnt vmcnt(23)
    v_perm_b32 v160, v36, v32, s66
    v_perm_b32 v164, v36, v32, s67
    v_perm_b32 v168, v37, v33, s66
    v_perm_b32 v172, v37, v33, s67
    v_perm_b32 v176, v38, v34, s66
    v_perm_b32 v180, v38, v34, s67
    v_perm_b32 v184, v39, v35, s66
    v_perm_b32 v188, v39, v35, s67
    s_waitcnt vmcnt(21)
    v_perm_b32 v161, v44, v40, s66
    v_perm_b32 v165, v44, v40, s67
    v_perm_b32 v169, v45, v41, s66
    v_perm_b32 v173, v45, v41, s67
    v_perm_b32 v177, v46, v42, s66
    v_perm_b32 v181, v46, v42, s67
    v_perm_b32 v185, v47, v43, s66
    v_perm_b32 v189, v47, v43, s67
    s_waitcnt vmcnt(19)
    v_perm_b32 v162, v52, v48, s66
    v_perm_b32 v166, v52, v48, s67
    v_perm_b32 v170, v53, v49, s66
    v_perm_b32 v174, v53, v49, s67
    v_perm_b32 v178, v54, v50, s66
    v_perm_b32 v182, v54, v50, s67
    v_perm_b32 v186, v55, v51, s66
    v_perm_b32 v190, v55, v51, s67
    s_waitcnt vmcnt(17)
    v_perm_b32 v163, v60, v56, s66
    v_perm_b32 v167, v60, v56, s67
    v_perm_b32 v171, v61, v57, s66
    v_perm_b32 v175, v61, v57, s67
    v_perm_b32 v179, v62, v58, s66
    v_perm_b32 v183, v62, v58, s67
    v_perm_b32 v187, v63, v59, s66
    v_perm_b32 v191, v63, v59, s67
    s_waitcnt vmcnt(15)
    v_perm_b32 v192, v68, v64, s66
    v_perm_b32 v196, v68, v64, s67
    v_perm_b32 v200, v69, v65, s66
    v_perm_b32 v204, v69, v65, s67
    v_perm_b32 v208, v70, v66, s66
    v_perm_b32 v212, v70, v66, s67
    v_perm_b32 v216, v71, v67, s66
    v_perm_b32 v220, v71, v67, s67
    s_waitcnt vmcnt(13)
    v_perm_b32 v193, v76, v72, s66
    v_perm_b32 v197, v76, v72, s67
    v_perm_b32 v201, v77, v73, s66
    v_perm_b32 v205, v77, v73, s67
    v_perm_b32 v209, v78, v74, s66
    v_perm_b32 v213, v78, v74, s67
    v_perm_b32 v217, v79, v75, s66
    v_perm_b32 v221, v79, v75, s67
    s_waitcnt vmcnt(11)
    v_perm_b32 v194, v84, v80, s66
    v_perm_b32 v198, v84, v80, s67
    v_perm_b32 v202, v85, v81, s66
    v_perm_b32 v206, v85, v81, s67
    v_perm_b32 v210, v86, v82, s66
    v_perm_b32 v214, v86, v82, s67
    v_perm_b32 v218, v87, v83, s66
    v_perm_b32 v222, v87, v83, s67
    s_waitcnt vmcnt(9)
    v_perm_b32 v195, v92, v88, s66
    v_perm_b32 v199, v92, v88, s67
    v_perm_b32 v203, v93, v89, s66
    v_perm_b32 v207, v93, v89, s67
    v_perm_b32 v211, v94, v90, s66
    v_perm_b32 v215, v94, v90, s67
    v_perm_b32 v219, v95, v91, s66
    v_perm_b32 v223, v95, v91, s67
    s_waitcnt vmcnt(7)
    v_perm_b32 v224, v100, v96, s66
    v_perm_b32 v228, v100, v96, s67
    v_perm_b32 v232, v101, v97, s66
    v_perm_b32 v236, v101, v97, s67
    v_perm_b32 v240, v102, v98, s66
    v_perm_b32 v244, v102, v98, s67
    v_perm_b32 v248, v103, v99, s66
    v_perm_b32 v252, v103, v99, s67
    s_waitcnt vmcnt(5)
    v_perm_b32 v225, v108, v104, s66
    v_perm_b32 v229, v108, v104, s67
    v_perm_b32 v233, v109, v105, s66
    v_perm_b32 v237, v109, v105, s67
    v_perm_b32 v241, v110, v106, s66
    v_perm_b32 v245, v110, v106, s67
    v_perm_b32 v249, v111, v107, s66
    v_perm_b32 v253, v111, v107, s67
    s_waitcnt vmcnt(3)
    v_perm_b32 v226, v116, v112, s66
    v_perm_b32 v230, v116, v112, s67
    v_perm_b32 v234, v117, v113, s66
    v_perm_b32 v238, v117, v113, s67
    v_perm_b32 v242, v118, v114, s66
    v_perm_b32 v246, v118, v114, s67
    v_perm_b32 v250, v119, v115, s66
    v_perm_b32 v254, v119, v115, s67
    s_waitcnt vmcnt(1)
    v_perm_b32 v227, v124, v120, s66
    v_perm_b32 v231, v124, v120, s67
    v_perm_b32 v235, v125, v121, s66
    v_perm_b32 v239, v125, v121, s67
    v_perm_b32 v243, v126, v122, s66
    v_perm_b32 v247, v126, v122, s67
    v_perm_b32 v251, v127, v123, s66
    v_perm_b32 v255, v127, v123, s67
    v_and_b32 v8, 1, v2
    v_lshlrev_b32 v8, 4, v8
    v_mov_b32 v27, 65535
    v_lshlrev_b32 v27, v8, v27
    v_bfe_u32 v8, v2, 1, 2
    v_cmp_eq_u32 vcc, 0, v8
    s_nop 1
    v_cndmask_b32 v24, 0, v27, vcc
    v_cmp_eq_u32 vcc, 1, v8
    s_nop 1
    v_cndmask_b32 v25, 0, v27, vcc
    v_cmp_eq_u32 vcc, 2, v8
    s_nop 1
    v_cndmask_b32 v26, 0, v27, vcc
    v_cmp_eq_u32 vcc, 3, v8
    s_nop 1
    v_cndmask_b32 v27, 0, v27, vcc
    v_lshrrev_b32 v8, 3, v0
    v_lshl_add_u32 v9, v8, 7, s53
    s_lshl_b32 s49, s38, 8
    s_add_u32 s55, s55, s49
    v_lshl_add_u32 v10, v8, 14, s55
    v_lshl_add_u32 v10, v7, 4, v10
    v_add_u32 v11, 131072, v10
    v_add_u32 v12, 262144, v10
    v_add_u32 v13, 393216, v10
    s_lshl_b32 s49, s38, 9
    v_lshl_add_u32 v14, v2, 4, s49
    v_and_b32 v8, 1, v3
    v_lshl_add_u32 v14, v8, 3, v14
    v_and_b32 v8, 1, v2
    v_lshl_add_u32 v15, v8, 7, s49
    v_lshl_add_u32 v15, v3, 4, v15
    v_xor_b32 v16, 64, v15
    s_lshl_b32 s49, s38, 8
    s_add_u32 s49, s49, 4096
    v_lshl_add_u32 v17, v2, 4, s49
    v_and_b32 v8, 3, v2
    v_lshlrev_b32 v18, 8, v8
    v_lshl_add_u32 v18, v3, 4, v18
    v_xor_b32 v19, 64, v18
    v_lshl_add_u32 v20, v2, 4, s52
    s_waitcnt vmcnt(0)
    v_cmp_ne_u32 vcc, s63, v31
    s_cbranch_vccz FD_34
    s_mov_b32 s69, 65536
FL_33:
    global_load_dword v31, v30, s[34:35] sc1
    s_waitcnt vmcnt(0)
    v_cmp_ne_u32 vcc, s63, v31
    s_cbranch_vccz FD_34
    s_sub_u32 s69, s69, 1
    s_cbranch_scc0 FL_33
FD_34:
    s_mov_b32 s69, 65536
PL_35:
    global_load_dwordx2 v[32:33], v9, s[34:35] offset:0 sc1
    global_load_dwordx2 v[34:35], v9, s[34:35] offset:1024 sc1
    global_load_dwordx2 v[36:37], v9, s[34:35] offset:2048 sc1
    global_load_dwordx2 v[38:39], v9, s[34:35] offset:3072 sc1
PC_36:
    s_waitcnt vmcnt(3)
    v_max_u32 v8, v32, v33
    s_waitcnt vmcnt(2)
    v_max3_u32 v8, v8, v34, v35
    s_waitcnt vmcnt(1)
    v_max3_u32 v8, v8, v36, v37
    s_waitcnt vmcnt(0)
    v_max3_u32 v8, v8, v38, v39
    v_cmp_eq_u32 vcc, -1, v8
    s_cbranch_vccz PD_37
    s_sub_u32 s69, s69, 1
    s_cbranch_scc0 PL_35
PD_37:
    global_load_dwordx4 v[64:67], v10, s[34:35] offset:0 sc1
    global_load_dwordx4 v[68:71], v11, s[34:35] offset:0 sc1
    global_load_dwordx4 v[72:75], v12, s[34:35] offset:0 sc1
    global_load_dwordx4 v[76:79], v13, s[34:35] offset:0 sc1
    v_max_f32 v40, v32, v34
    v_max3_f32 v40, v40, v36, v38
    s_nop 1
    v_max_f32_dpp v40, v40, v40 row_ror:8 row_mask:0xf bank_mask:0xf
    v_mov_b32 v41, v40
    s_nop 1
    v_permlane16_swap_b32 v40, v41
    v_max_f32 v40, v40, v41
    v_mov_b32 v41, v40
    s_nop 1
    v_permlane32_swap_b32 v40, v41
    v_max_f32 v40, v40, v41
    v_sub_f32 v32, v32, v40
    v_sub_f32 v34, v34, v40
    v_sub_f32 v36, v36, v40
    v_sub_f32 v38, v38, v40
    v_exp_f32 v32, v32
    v_exp_f32 v34, v34
    v_exp_f32 v36, v36
    v_exp_f32 v38, v38
    v_cvt_pk_bf16_f32 v32, v32, v32
    v_cvt_pk_bf16_f32 v34, v34, v34
    v_cvt_pk_bf16_f32 v36, v36, v36
    v_cvt_pk_bf16_f32 v38, v38, v38
    v_and_b32 v48, v24, v32
    v_and_b32 v49, v25, v32
    v_and_b32 v50, v26, v32
    v_and_b32 v51, v27, v32
    v_and_b32 v52, v24, v34
    v_and_b32 v53, v25, v34
    v_and_b32 v54, v26, v34
    v_and_b32 v55, v27, v34
    v_and_b32 v56, v24, v36
    v_and_b32 v57, v25, v36
    v_and_b32 v58, v26, v36
    v_and_b32 v59, v27, v36
    v_and_b32 v60, v24, v38
    v_and_b32 v61, v25, v38
    v_and_b32 v62, v26, v38
    v_and_b32 v63, v27, v38
    v_and_b32 v32, 0xffff0000, v32
    v_and_b32 v34, 0xffff0000, v34
    v_and_b32 v36, 0xffff0000, v36
    v_and_b32 v38, 0xffff0000, v38
    v_mul_f32 v40, v32, v33
    v_fmac_f32 v40, v34, v35
    v_fmac_f32 v40, v36, v37
    v_fmac_f32 v40, v38, v39
    s_nop 1
    v_add_f32_dpp v40, v40, v40 row_ror:8 row_mask:0xf bank_mask:0xf
    v_mov_b32 v41, v40
    s_nop 1
    v_permlane16_swap_b32 v40, v41
    v_add_f32 v40, v40, v41
    v_mov_b32 v41, v40
    s_nop 1
    v_permlane32_swap_b32 v40, v41
    v_add_f32 v40, v40, v41
    v_rcp_f32 v40, v40
    s_mov_b32 s69, 65536
    s_branch PC_39
PL_38:
    global_load_dwordx4 v[64:67], v10, s[34:35] offset:0 sc1
    global_load_dwordx4 v[68:71], v11, s[34:35] offset:0 sc1
    global_load_dwordx4 v[72:75], v12, s[34:35] offset:0 sc1
    global_load_dwordx4 v[76:79], v13, s[34:35] offset:0 sc1
PC_39:
    s_waitcnt vmcnt(3)
    v_max_u32 v8, v64, v65
    v_max3_u32 v8, v8, v66, v67
    s_waitcnt vmcnt(2)
    v_max3_u32 v8, v8, v68, v69
    v_max3_u32 v8, v8, v70, v71
    s_waitcnt vmcnt(1)
    v_max3_u32 v8, v8, v72, v73
    v_max3_u32 v8, v8, v74, v75
    s_waitcnt vmcnt(0)
    v_max3_u32 v8, v8, v76, v77
    v_max3_u32 v8, v8, v78, v79
    v_cmp_eq_u32 vcc, -1, v8
    s_cbranch_vccz PD_40
    s_sub_u32 s69, s69, 1
    s_cbranch_scc0 PL_38
PD_40:
    global_load_dwordx4 v[80:83], v10, s[34:35] offset:128 sc1
    global_load_dwordx4 v[84:87], v11, s[34:35] offset:128 sc1
    global_load_dwordx4 v[88:91], v12, s[34:35] offset:128 sc1
    global_load_dwordx4 v[92:95], v13, s[34:35] offset:128 sc1
    v_mfma_f32_16x16x32_bf16 v[44:47], v[48:51], v[64:67], 0
    v_mfma_f32_16x16x32_bf16 v[44:47], v[52:55], v[68:71], v[44:47]
    v_mfma_f32_16x16x32_bf16 v[44:47], v[56:59], v[72:75], v[44:47]
    v_mfma_f32_16x16x32_bf16 v[44:47], v[60:63], v[76:79], v[44:47]
    s_nop 7
    v_pk_mul_f32 v[44:45], v[44:45], v[40:41] op_sel_hi:[1,0]
    v_pk_mul_f32 v[46:47], v[46:47], v[40:41] op_sel_hi:[1,0]
    v_cvt_pk_bf16_f32 v42, v44, v45
    v_cvt_pk_bf16_f32 v43, v46, v47
    s_mov_b32 exec_lo, 0x00ff00ff
    s_mov_b32 exec_hi, 0xff00ff00
    ds_write_b64 v14, v[42:43] offset:0
    s_mov_b64 exec, -1
    s_cmp_eq_u32 s62, 1
    ds_read_b128 v[32:35], v15 offset:0
    ds_read_b128 v[36:39], v16 offset:0
    s_cbranch_scc1 EU_41
    s_waitcnt lgkmcnt(1)
    v_mfma_f32_16x16x32_bf16 v[96:99], v[32:35], a[0:3], 0
    v_mfma_f32_16x16x32_bf16 v[100:103], v[32:35], a[4:7], 0
    v_mfma_f32_16x16x32_bf16 v[104:107], v[32:35], a[8:11], 0
    v_mfma_f32_16x16x32_bf16 v[108:111], v[32:35], a[12:15], 0
    v_mfma_f32_16x16x32_bf16 v[112:115], v[32:35], a[16:19], 0
    v_mfma_f32_16x16x32_bf16 v[116:119], v[32:35], a[20:23], 0
    v_mfma_f32_16x16x32_bf16 v[120:123], v[32:35], a[24:27], 0
    v_mfma_f32_16x16x32_bf16 v[124:127], v[32:35], a[28:31], 0
    s_waitcnt lgkmcnt(0)
    v_mfma_f32_16x16x32_bf16 v[96:99], v[36:39], a[32:35], v[96:99]
    v_mfma_f32_16x16x32_bf16 v[100:103], v[36:39], a[36:39], v[100:103]
    v_mfma_f32_16x16x32_bf16 v[104:107], v[36:39], a[40:43], v[104:107]
    v_mfma_f32_16x16x32_bf16 v[108:111], v[36:39], a[44:47], v[108:111]
    v_mfma_f32_16x16x32_bf16 v[112:115], v[36:39], a[48:51], v[112:115]
    v_mfma_f32_16x16x32_bf16 v[116:119], v[36:39], a[52:55], v[116:119]
    v_mfma_f32_16x16x32_bf16 v[120:123], v[36:39], a[56:59], v[120:123]
    v_mfma_f32_16x16x32_bf16 v[124:127], v[36:39], a[60:63], v[124:127]
    s_branch EV_42
EU_41:
    s_waitcnt lgkmcnt(1)
    v_mfma_f32_16x16x32_bf16 v[96:99], v[32:35], v[128:131], 0
    v_mfma_f32_16x16x32_bf16 v[100:103], v[32:35], v[132:135], 0
    v_mfma_f32_16x16x32_bf16 v[104:107], v[32:35], v[136:139], 0
    v_mfma_f32_16x16x32_bf16 v[108:111], v[32:35], v[140:143], 0
    v_mfma_f32_16x16x32_bf16 v[112:115], v[32:35], v[144:147], 0
    v_mfma_f32_16x16x32_bf16 v[116:119], v[32:35], v[148:151], 0
    v_mfma_f32_16x16x32_bf16 v[120:123], v[32:35], v[152:155], 0
    v_mfma_f32_16x16x32_bf16 v[124:127], v[32:35], v[156:159], 0
    s_waitcnt lgkmcnt(0)
    v_mfma_f32_16x16x32_bf16 v[96:99], v[36:39], v[160:163], v[96:99]
    v_mfma_f32_16x16x32_bf16 v[100:103], v[36:39], v[164:167], v[100:103]
    v_mfma_f32_16x16x32_bf16 v[104:107], v[36:39], v[168:171], v[104:107]
    v_mfma_f32_16x16x32_bf16 v[108:111], v[36:39], v[172:175], v[108:111]
    v_mfma_f32_16x16x32_bf16 v[112:115], v[36:39], v[176:179], v[112:115]
    v_mfma_f32_16x16x32_bf16 v[116:119], v[36:39], v[180:183], v[116:119]
    v_mfma_f32_16x16x32_bf16 v[120:123], v[36:39], v[184:187], v[120:123]
    v_mfma_f32_16x16x32_bf16 v[124:127], v[36:39], v[188:191], v[124:127]
EV_42:
    s_mov_b32 s69, 65536
    s_branch PC_44
PL_43:
    global_load_dwordx4 v[80:83], v10, s[34:35] offset:128 sc1
    global_load_dwordx4 v[84:87], v11, s[34:35] offset:128 sc1
    global_load_dwordx4 v[88:91], v12, s[34:35] offset:128 sc1
    global_load_dwordx4 v[92:95], v13, s[34:35] offset:128 sc1
PC_44:
    s_waitcnt vmcnt(3)
    v_max_u32 v8, v80, v81
    v_max3_u32 v8, v8, v82, v83
    s_waitcnt vmcnt(2)
    v_max3_u32 v8, v8, v84, v85
    v_max3_u32 v8, v8, v86, v87
    s_waitcnt vmcnt(1)
    v_max3_u32 v8, v8, v88, v89
    v_max3_u32 v8, v8, v90, v91
    s_waitcnt vmcnt(0)
    v_max3_u32 v8, v8, v92, v93
    v_max3_u32 v8, v8, v94, v95
    v_cmp_eq_u32 vcc, -1, v8
    s_cbranch_vccz PD_45
    s_sub_u32 s69, s69, 1
    s_cbranch_scc0 PL_43
PD_45:
    v_mfma_f32_16x16x32_bf16 v[44:47], v[48:51], v[80:83], 0
    v_mfma_f32_16x16x32_bf16 v[44:47], v[52:55], v[84:87], v[44:47]
    v_mfma_f32_16x16x32_bf16 v[44:47], v[56:59], v[88:91], v[44:47]
    v_mfma_f32_16x16x32_bf16 v[44:47], v[60:63], v[92:95], v[44:47]
    s_nop 7
    v_pk_mul_f32 v[44:45], v[44:45], v[40:41] op_sel_hi:[1,0]
    v_pk_mul_f32 v[46:47], v[46:47], v[40:41] op_sel_hi:[1,0]
    v_cvt_pk_bf16_f32 v42, v44, v45
    v_cvt_pk_bf16_f32 v43, v46, v47
    s_mov_b32 exec_lo, 0x00ff00ff
    s_mov_b32 exec_hi, 0xff00ff00
    ds_write_b64 v14, v[42:43] offset:256
    s_mov_b64 exec, -1
    s_cmp_eq_u32 s62, 1
    ds_read_b128 v[32:35], v15 offset:256
    ds_read_b128 v[36:39], v16 offset:256
    s_cbranch_scc1 EU_46
    s_waitcnt lgkmcnt(1)
    v_mfma_f32_16x16x32_bf16 v[96:99], v[32:35], a[64:67], v[96:99]
    v_mfma_f32_16x16x32_bf16 v[100:103], v[32:35], a[68:71], v[100:103]
    v_mfma_f32_16x16x32_bf16 v[104:107], v[32:35], a[72:75], v[104:107]
    v_mfma_f32_16x16x32_bf16 v[108:111], v[32:35], a[76:79], v[108:111]
    v_mfma_f32_16x16x32_bf16 v[112:115], v[32:35], a[80:83], v[112:115]
    v_mfma_f32_16x16x32_bf16 v[116:119], v[32:35], a[84:87], v[116:119]
    v_mfma_f32_16x16x32_bf16 v[120:123], v[32:35], a[88:91], v[120:123]
    v_mfma_f32_16x16x32_bf16 v[124:127], v[32:35], a[92:95], v[124:127]
    s_waitcnt lgkmcnt(0)
    v_mfma_f32_16x16x32_bf16 v[96:99], v[36:39], a[96:99], v[96:99]
    v_mfma_f32_16x16x32_bf16 v[100:103], v[36:39], a[100:103], v[100:103]
    v_mfma_f32_16x16x32_bf16 v[104:107], v[36:39], a[104:107], v[104:107]
    v_mfma_f32_16x16x32_bf16 v[108:111], v[36:39], a[108:111], v[108:111]
    v_mfma_f32_16x16x32_bf16 v[112:115], v[36:39], a[112:115], v[112:115]
    v_mfma_f32_16x16x32_bf16 v[116:119], v[36:39], a[116:119], v[116:119]
    v_mfma_f32_16x16x32_bf16 v[120:123], v[36:39], a[120:123], v[120:123]
    v_mfma_f32_16x16x32_bf16 v[124:127], v[36:39], a[124:127], v[124:127]
    s_branch EV_47
EU_46:
    s_waitcnt lgkmcnt(1)
    v_mfma_f32_16x16x32_bf16 v[96:99], v[32:35], v[192:195], v[96:99]
    v_mfma_f32_16x16x32_bf16 v[100:103], v[32:35], v[196:199], v[100:103]
    v_mfma_f32_16x16x32_bf16 v[104:107], v[32:35], v[200:203], v[104:107]
    v_mfma_f32_16x16x32_bf16 v[108:111], v[32:35], v[204:207], v[108:111]
    v_mfma_f32_16x16x32_bf16 v[112:115], v[32:35], v[208:211], v[112:115]
    v_mfma_f32_16x16x32_bf16 v[116:119], v[32:35], v[212:215], v[116:119]
    v_mfma_f32_16x16x32_bf16 v[120:123], v[32:35], v[216:219], v[120:123]
    v_mfma_f32_16x16x32_bf16 v[124:127], v[32:35], v[220:223], v[124:127]
    s_waitcnt lgkmcnt(0)
    v_mfma_f32_16x16x32_bf16 v[96:99], v[36:39], v[224:227], v[96:99]
    v_mfma_f32_16x16x32_bf16 v[100:103], v[36:39], v[228:231], v[100:103]
    v_mfma_f32_16x16x32_bf16 v[104:107], v[36:39], v[232:235], v[104:107]
    v_mfma_f32_16x16x32_bf16 v[108:111], v[36:39], v[236:239], v[108:111]
    v_mfma_f32_16x16x32_bf16 v[112:115], v[36:39], v[240:243], v[112:115]
    v_mfma_f32_16x16x32_bf16 v[116:119], v[36:39], v[244:247], v[116:119]
    v_mfma_f32_16x16x32_bf16 v[120:123], v[36:39], v[248:251], v[120:123]
    v_mfma_f32_16x16x32_bf16 v[124:127], v[36:39], v[252:255], v[124:127]
EV_47:
    s_nop 0
    v_add_f32 v96, v96, v97
    v_add_f32 v100, v100, v101
    v_add_f32 v104, v104, v105
    v_add_f32 v108, v108, v109
    v_add_f32 v112, v112, v113
    v_add_f32 v116, v116, v117
    v_add_f32 v120, v120, v121
    v_add_f32 v124, v124, v125
    v_cvt_pk_bf16_f32 v32, v96, v100
    v_cvt_pk_bf16_f32 v33, v104, v108
    v_cvt_pk_bf16_f32 v34, v112, v116
    v_cvt_pk_bf16_f32 v35, v120, v124
    s_mov_b64 exec, 0xffff
    ds_write_b128 v17, v[32:35]
    s_mov_b64 exec, -1
    s_waitcnt lgkmcnt(0)
    s_barrier
    ds_read_b128 v[64:67], v18 offset:4096
    ds_read_b128 v[68:71], v19 offset:4096
    ds_read_b128 v[72:75], v18 offset:4224
    ds_read_b128 v[76:79], v19 offset:4224
    s_cbranch_scc1 EU_48
    s_waitcnt lgkmcnt(3)
    v_mfma_f32_16x16x32_bf16 v[96:99], v[64:67], v[128:131], 0
    v_mfma_f32_16x16x32_bf16 v[100:103], v[64:67], v[132:135], 0
    v_mfma_f32_16x16x32_bf16 v[104:107], v[64:67], v[136:139], 0
    v_mfma_f32_16x16x32_bf16 v[108:111], v[64:67], v[140:143], 0
    v_mfma_f32_16x16x32_bf16 v[112:115], v[64:67], v[144:147], 0
    v_mfma_f32_16x16x32_bf16 v[116:119], v[64:67], v[148:151], 0
    v_mfma_f32_16x16x32_bf16 v[120:123], v[64:67], v[152:155], 0
    v_mfma_f32_16x16x32_bf16 v[124:127], v[64:67], v[156:159], 0
    s_waitcnt lgkmcnt(2)
    v_mfma_f32_16x16x32_bf16 v[96:99], v[68:71], v[160:163], v[96:99]
    v_mfma_f32_16x16x32_bf16 v[100:103], v[68:71], v[164:167], v[100:103]
    v_mfma_f32_16x16x32_bf16 v[104:107], v[68:71], v[168:171], v[104:107]
    v_mfma_f32_16x16x32_bf16 v[108:111], v[68:71], v[172:175], v[108:111]
    v_mfma_f32_16x16x32_bf16 v[112:115], v[68:71], v[176:179], v[112:115]
    v_mfma_f32_16x16x32_bf16 v[116:119], v[68:71], v[180:183], v[116:119]
    v_mfma_f32_16x16x32_bf16 v[120:123], v[68:71], v[184:187], v[120:123]
    v_mfma_f32_16x16x32_bf16 v[124:127], v[68:71], v[188:191], v[124:127]
    s_waitcnt lgkmcnt(1)
    v_mfma_f32_16x16x32_bf16 v[96:99], v[72:75], v[192:195], v[96:99]
    v_mfma_f32_16x16x32_bf16 v[100:103], v[72:75], v[196:199], v[100:103]
    v_mfma_f32_16x16x32_bf16 v[104:107], v[72:75], v[200:203], v[104:107]
    v_mfma_f32_16x16x32_bf16 v[108:111], v[72:75], v[204:207], v[108:111]
    v_mfma_f32_16x16x32_bf16 v[112:115], v[72:75], v[208:211], v[112:115]
    v_mfma_f32_16x16x32_bf16 v[116:119], v[72:75], v[212:215], v[116:119]
    v_mfma_f32_16x16x32_bf16 v[120:123], v[72:75], v[216:219], v[120:123]
    v_mfma_f32_16x16x32_bf16 v[124:127], v[72:75], v[220:223], v[124:127]
    s_waitcnt lgkmcnt(0)
    v_mfma_f32_16x16x32_bf16 v[96:99], v[76:79], v[224:227], v[96:99]
    v_mfma_f32_16x16x32_bf16 v[100:103], v[76:79], v[228:231], v[100:103]
    v_mfma_f32_16x16x32_bf16 v[104:107], v[76:79], v[232:235], v[104:107]
    v_mfma_f32_16x16x32_bf16 v[108:111], v[76:79], v[236:239], v[108:111]
    v_mfma_f32_16x16x32_bf16 v[112:115], v[76:79], v[240:243], v[112:115]
    v_mfma_f32_16x16x32_bf16 v[116:119], v[76:79], v[244:247], v[116:119]
    v_mfma_f32_16x16x32_bf16 v[120:123], v[76:79], v[248:251], v[120:123]
    v_mfma_f32_16x16x32_bf16 v[124:127], v[76:79], v[252:255], v[124:127]
    s_branch EV_49
EU_48:
    s_waitcnt lgkmcnt(3)
    v_mfma_f32_16x16x32_bf16 v[96:99], v[64:67], a[0:3], 0
    v_mfma_f32_16x16x32_bf16 v[100:103], v[64:67], a[4:7], 0
    v_mfma_f32_16x16x32_bf16 v[104:107], v[64:67], a[8:11], 0
    v_mfma_f32_16x16x32_bf16 v[108:111], v[64:67], a[12:15], 0
    v_mfma_f32_16x16x32_bf16 v[112:115], v[64:67], a[16:19], 0
    v_mfma_f32_16x16x32_bf16 v[116:119], v[64:67], a[20:23], 0
    v_mfma_f32_16x16x32_bf16 v[120:123], v[64:67], a[24:27], 0
    v_mfma_f32_16x16x32_bf16 v[124:127], v[64:67], a[28:31], 0
    s_waitcnt lgkmcnt(2)
    v_mfma_f32_16x16x32_bf16 v[96:99], v[68:71], a[32:35], v[96:99]
    v_mfma_f32_16x16x32_bf16 v[100:103], v[68:71], a[36:39], v[100:103]
    v_mfma_f32_16x16x32_bf16 v[104:107], v[68:71], a[40:43], v[104:107]
    v_mfma_f32_16x16x32_bf16 v[108:111], v[68:71], a[44:47], v[108:111]
    v_mfma_f32_16x16x32_bf16 v[112:115], v[68:71], a[48:51], v[112:115]
    v_mfma_f32_16x16x32_bf16 v[116:119], v[68:71], a[52:55], v[116:119]
    v_mfma_f32_16x16x32_bf16 v[120:123], v[68:71], a[56:59], v[120:123]
    v_mfma_f32_16x16x32_bf16 v[124:127], v[68:71], a[60:63], v[124:127]
    s_waitcnt lgkmcnt(1)
    v_mfma_f32_16x16x32_bf16 v[96:99], v[72:75], a[64:67], v[96:99]
    v_mfma_f32_16x16x32_bf16 v[100:103], v[72:75], a[68:71], v[100:103]
    v_mfma_f32_16x16x32_bf16 v[104:107], v[72:75], a[72:75], v[104:107]
    v_mfma_f32_16x16x32_bf16 v[108:111], v[72:75], a[76:79], v[108:111]
    v_mfma_f32_16x16x32_bf16 v[112:115], v[72:75], a[80:83], v[112:115]
    v_mfma_f32_16x16x32_bf16 v[116:119], v[72:75], a[84:87], v[116:119]
    v_mfma_f32_16x16x32_bf16 v[120:123], v[72:75], a[88:91], v[120:123]
    v_mfma_f32_16x16x32_bf16 v[124:127], v[72:75], a[92:95], v[124:127]
    s_waitcnt lgkmcnt(0)
    v_mfma_f32_16x16x32_bf16 v[96:99], v[76:79], a[96:99], v[96:99]
    v_mfma_f32_16x16x32_bf16 v[100:103], v[76:79], a[100:103], v[100:103]
    v_mfma_f32_16x16x32_bf16 v[104:107], v[76:79], a[104:107], v[104:107]
    v_mfma_f32_16x16x32_bf16 v[108:111], v[76:79], a[108:111], v[108:111]
    v_mfma_f32_16x16x32_bf16 v[112:115], v[76:79], a[112:115], v[112:115]
    v_mfma_f32_16x16x32_bf16 v[116:119], v[76:79], a[116:119], v[116:119]
    v_mfma_f32_16x16x32_bf16 v[120:123], v[76:79], a[120:123], v[120:123]
    v_mfma_f32_16x16x32_bf16 v[124:127], v[76:79], a[124:127], v[124:127]
EV_49:
    s_nop 0
    v_pk_add_f32 v[96:97], v[96:97], v[98:99]
    v_add_f32 v96, v96, v97
    v_pk_add_f32 v[100:101], v[100:101], v[102:103]
    v_add_f32 v100, v100, v101
    v_pk_add_f32 v[104:105], v[104:105], v[106:107]
    v_add_f32 v104, v104, v105
    v_pk_add_f32 v[108:109], v[108:109], v[110:111]
    v_add_f32 v108, v108, v109
    v_pk_add_f32 v[112:113], v[112:113], v[114:115]
    v_add_f32 v112, v112, v113
    v_pk_add_f32 v[116:117], v[116:117], v[118:119]
    v_add_f32 v116, v116, v117
    v_pk_add_f32 v[120:121], v[120:121], v[122:123]
    v_add_f32 v120, v120, v121
    v_pk_add_f32 v[124:125], v[124:125], v[126:127]
    v_add_f32 v124, v124, v125
    v_cvt_pk_bf16_f32 v32, v96, v100
    v_cvt_pk_bf16_f32 v33, v104, v108
    v_cvt_pk_bf16_f32 v34, v112, v116
    v_cvt_pk_bf16_f32 v35, v120, v124
    s_mov_b64 exec, 0xffff
    global_store_dwordx4 v20, v[32:35], s[34:35] sc1
    s_mov_b64 exec, -1
    s_branch FIN
ROLE_A:
    s_sub_u32 s40, s37, 15
    s_mov_b32 s39, s40
    s_lshl_b32 s46, s36, 10
    s_lshl_b32 s47, s38, 20
    s_add_u32 s46, s46, s47
    s_and_b32 s47, s39, 8
    s_add_u32 s47, s47, s39
    s_add_u32 s47, s47, 8
    s_lshl_b32 s47, s47, 15
    s_add_u32 s47, s47, s46
    v_add_u32 v8, s47, v4
    v_lshlrev_b32 v9, 13, v3
    v_lshl_add_u32 v9, v2, 3, v9
    s_lshl_b32 s48, s39, 16
    s_add_u32 s48, s48, s46
    v_add_u32 v10, s48, v9
    v_add_u32 v9, s47, v9
    v_add_u32 v11, -262144, v9
    v_add_u32 v12, 32768, v10
    s_waitcnt lgkmcnt(0)
    global_load_dwordx2 v[112:113], v11, s[8:9] offset:384
    global_load_dwordx2 v[114:115], v9, s[8:9] offset:384
    global_load_dwordx2 v[116:117], v10, s[10:11] offset:384
    global_load_dwordx2 v[118:119], v12, s[10:11] offset:384
    global_load_dwordx4 v[96:99], v8, s[8:9]
    v_add_u32 v8, 8192, v8
    global_load_dwordx4 v[100:103], v8, s[8:9]
    v_add_u32 v8, 8192, v8
    global_load_dwordx4 v[104:107], v8, s[8:9]
    v_add_u32 v8, 8192, v8
    global_load_dwordx4 v[108:111], v8, s[8:9]
    v_add_u32 v8, 8192, v8
    s_mul_i32 s47, s39, 65536
    s_add_u32 s46, s46, s47
    s_add_u32 s46, s46, 0
    v_add_u32 v8, s46, v4
    global_load_dwordx4 v[64:67], v8, s[10:11]
    v_add_u32 v8, 8192, v8
    global_load_dwordx4 v[68:71], v8, s[10:11]
    v_add_u32 v8, 8192, v8
    global_load_dwordx4 v[72:75], v8, s[10:11]
    v_add_u32 v8, 8192, v8
    global_load_dwordx4 v[76:79], v8, s[10:11]
    v_add_u32 v8, 8192, v8
    global_load_dwordx4 v[80:83], v8, s[10:11]
    v_add_u32 v8, 8192, v8
    global_load_dwordx4 v[84:87], v8, s[10:11]
    v_add_u32 v8, 8192, v8
    global_load_dwordx4 v[88:91], v8, s[10:11]
    v_add_u32 v8, 8192, v8
    global_load_dwordx4 v[92:95], v8, s[10:11]
    v_add_u32 v8, 8192, v8
    s_and_b32 s50, s40, 1
    s_lshr_b32 s40, s40, 1
    s_lshl_b32 s40, s40, 3
    s_add_u32 s51, s36, 0
    s_and_b32 s51, s51, 7
    s_add_u32 s51, s40, s51
    s_lshl_b32 s41, s51, 18
    s_mul_i32 s43, s50, 4194304
    s_and_b32 s41, s41, 0x800000
    s_and_b32 s42, s51, 31
    s_lshl_b32 s42, s42, 14
    s_xor_b32 s43, s43, s42
    s_lshl_b32 s42, s38, 12
    s_add_u32 s41, s41, s42
    v_add_u32 v5, s43, v4
    s_mul_i32 s42, s38, 4224
    s_add_u32 s44, s6, s41
    s_addc_u32 s45, s7, 0
    v_xor_b32 v8, 0, v5
    s_add_u32 m0, s42, 0
    s_nop 0
    global_load_lds_dwordx4 v8, s[44:45] offset:0
    s_add_u32 m0, s42, 32
    s_nop 0
    global_load_lds_dwordx4 v8, s[44:45] offset:1024
    s_add_u32 m0, s42, 64
    s_nop 0
    global_load_lds_dwordx4 v8, s[44:45] offset:2048
    s_add_u32 m0, s42, 96
    s_nop 0
    global_load_lds_dwordx4 v8, s[44:45] offset:3072
    v_xor_b32 v8, 524288, v5
    s_add_u32 m0, s42, 16896
    s_nop 0
    global_load_lds_dwordx4 v8, s[44:45] offset:0
    s_add_u32 m0, s42, 16928
    s_nop 0
    global_load_lds_dwordx4 v8, s[44:45] offset:1024
    s_add_u32 m0, s42, 16960
    s_nop 0
    global_load_lds_dwordx4 v8, s[44:45] offset:2048
    s_add_u32 m0, s42, 16992
    s_nop 0
    global_load_lds_dwordx4 v8, s[44:45] offset:3072
    v_xor_b32 v8, 1048576, v5
    s_add_u32 m0, s42, 33792
    s_nop 0
    global_load_lds_dwordx4 v8, s[44:45] offset:0
    s_add_u32 m0, s42, 33824
    s_nop 0
    global_load_lds_dwordx4 v8, s[44:45] offset:1024
    s_add_u32 m0, s42, 33856
    s_nop 0
    global_load_lds_dwordx4 v8, s[44:45] offset:2048
    s_add_u32 m0, s42, 33888
    s_nop 0
    global_load_lds_dwordx4 v8, s[44:45] offset:3072
    v_xor_b32 v8, 1572864, v5
    s_add_u32 m0, s42, 50688
    s_nop 0
    global_load_lds_dwordx4 v8, s[44:45] offset:0
    s_add_u32 m0, s42, 50720
    s_nop 0
    global_load_lds_dwordx4 v8, s[44:45] offset:1024
    s_add_u32 m0, s42, 50752
    s_nop 0
    global_load_lds_dwordx4 v8, s[44:45] offset:2048
    s_add_u32 m0, s42, 50784
    s_nop 0
    global_load_lds_dwordx4 v8, s[44:45] offset:3072
    v_lshrrev_b32 v9, 2, v0
    v_mul_u32_u24 v9, 1056, v9
    v_and_b32 v10, 3, v0
    v_lshl_add_u32 v9, v10, 3, v9
    s_lshl_b32 s43, s38, 8
    v_add_u32 v9, s43, v9
    v_add_u32 v10, 67584, v9
    v_mul_u32_u24 v13, 1056, v2
    v_lshl_add_u32 v13, v3, 4, v13
    s_mul_i32 s49, s38, 16896
    v_add_u32 v11, s49, v13
    v_add_u32 v12, 67584, v11
    v_add_u32 v13, 135168, v13
    s_lshr_b32 s52, s51, 5
    s_and_b32 s53, s51, 31
    s_lshl_b32 s52, s52, 1
    s_add_u32 s52, s52, s50
    s_lshl_b32 s49, s52, 14
    s_lshl_b32 s41, s38, 12
    s_add_u32 s49, s49, s41
    s_add_u32 s49, s49, 262144
    v_add_u32 v14, s49, v4
    s_lshr_b32 s48, s52, 1
    s_mul_i32 s49, s48, 384
    s_add_u32 s49, s49, 524160
    s_mov_b32 exec_lo, 0xffff0000
    s_mov_b32 exec_hi, 0
    v_add_u32 v14, s49, v14
    s_mov_b64 exec, -1
    s_add_u32 s49, s42, 135168
    v_add_u32 v15, s49, v4
    s_lshl_b32 s56, s52, 5
    s_add_u32 s56, s56, s53
    s_lshl_b32 s57, s56, 7
    s_add_u32 s57, s57, 196608
    s_lshl_b32 s56, s56, 14
    s_add_u32 s56, s56, 1048576
    s_add_u32 s49, s56, s41
    v_add_u32 v16, s49, v4
    s_mul_i32 s49, s48, -1048192
    s_add_u32 s49, s49, 2097024
    s_mov_b32 exec_lo, 0xffff0000
    s_mov_b32 exec_hi, 0
    v_add_u32 v16, s49, v16
    s_mov_b64 exec, -1
    s_mul_i32 s49, s48, -1048192
    s_add_u32 s49, s49, 2097024
    s_cmp_eq_u32 s38, 1
    s_cselect_b32 s49, s49, 0
    s_add_u32 s56, s56, s49
    v_add_u32 v17, s57, v1
    v_mov_b32 v30, -1
    v_mov_b32 v31, -1
    s_load_dword s63, s[34:35], 261120
    s_lshl_b32 s49, s50, 9
    s_add_u32 s49, s49, 236544
    v_bfe_u32 v26, v0, 2, 3
    v_lshl_add_u32 v26, v26, 10, s49
    v_and_b32 v27, 3, v0
    v_lshl_add_u32 v26, v27, 7, v26
    v_subrev_u32 v25, 131072, v14
    s_waitcnt vmcnt(12)
    s_waitcnt lgkmcnt(0)
    s_barrier
    s_mul_i32 s63, s63, 0x9e3779b1
    s_add_u32 s63, s63, 0x7f4a7c15
    v_xor_b32 v8, 2359296, v5
    s_add_u32 m0, s42, 67584
    s_nop 0
    global_load_lds_dwordx4 v8, s[44:45] offset:0
    s_add_u32 m0, s42, 67616
    s_nop 0
    global_load_lds_dwordx4 v8, s[44:45] offset:1024
    s_add_u32 m0, s42, 67648
    s_nop 0
    global_load_lds_dwordx4 v8, s[44:45] offset:2048
    s_add_u32 m0, s42, 67680
    s_nop 0
    global_load_lds_dwordx4 v8, s[44:45] offset:3072
    ds_read_b64_tr_b16 v[128:129], v9 offset:0
    ds_read_b64_tr_b16 v[132:133], v9 offset:32
    ds_read_b64_tr_b16 v[136:137], v9 offset:64
    ds_read_b64_tr_b16 v[140:141], v9 offset:96
    ds_read_b64_tr_b16 v[144:145], v9 offset:128
    ds_read_b64_tr_b16 v[148:149], v9 offset:160
    ds_read_b64_tr_b16 v[152:153], v9 offset:192
    ds_read_b64_tr_b16 v[156:157], v9 offset:224
    s_waitcnt vmcnt(12)
    s_waitcnt lgkmcnt(0)
    s_barrier
    v_xor_b32 v8, 2883584, v5
    s_add_u32 m0, s42, 84480
    s_nop 0
    global_load_lds_dwordx4 v8, s[44:45] offset:0
    s_add_u32 m0, s42, 84512
    s_nop 0
    global_load_lds_dwordx4 v8, s[44:45] offset:1024
    s_add_u32 m0, s42, 84544
    s_nop 0
    global_load_lds_dwordx4 v8, s[44:45] offset:2048
    s_add_u32 m0, s42, 84576
    s_nop 0
    global_load_lds_dwordx4 v8, s[44:45] offset:3072
    ds_read_b64_tr_b16 v[160:161], v9 offset:16896
    ds_read_b64_tr_b16 v[164:165], v9 offset:16928
    ds_read_b64_tr_b16 v[168:169], v9 offset:16960
    ds_read_b64_tr_b16 v[172:173], v9 offset:16992
    ds_read_b64_tr_b16 v[176:177], v9 offset:17024
    ds_read_b64_tr_b16 v[180:181], v9 offset:17056
    ds_read_b64_tr_b16 v[184:185], v9 offset:17088
    ds_read_b64_tr_b16 v[188:189], v9 offset:17120
    s_waitcnt vmcnt(12)
    s_waitcnt lgkmcnt(0)
    s_barrier
    v_xor_b32 v8, 3407872, v5
    s_add_u32 m0, s42, 101376
    s_nop 0
    global_load_lds_dwordx4 v8, s[44:45] offset:0
    s_add_u32 m0, s42, 101408
    s_nop 0
    global_load_lds_dwordx4 v8, s[44:45] offset:1024
    s_add_u32 m0, s42, 101440
    s_nop 0
    global_load_lds_dwordx4 v8, s[44:45] offset:2048
    s_add_u32 m0, s42, 101472
    s_nop 0
    global_load_lds_dwordx4 v8, s[44:45] offset:3072
    ds_read_b64_tr_b16 v[192:193], v9 offset:33792
    ds_read_b64_tr_b16 v[196:197], v9 offset:33824
    ds_read_b64_tr_b16 v[200:201], v9 offset:33856
    ds_read_b64_tr_b16 v[204:205], v9 offset:33888
    ds_read_b64_tr_b16 v[208:209], v9 offset:33920
    ds_read_b64_tr_b16 v[212:213], v9 offset:33952
    ds_read_b64_tr_b16 v[216:217], v9 offset:33984
    ds_read_b64_tr_b16 v[220:221], v9 offset:34016
    s_waitcnt vmcnt(12)
    s_waitcnt lgkmcnt(0)
    s_barrier
    v_xor_b32 v8, 3932160, v5
    s_add_u32 m0, s42, 118272
    s_nop 0
    global_load_lds_dwordx4 v8, s[44:45] offset:0
    s_add_u32 m0, s42, 118304
    s_nop 0
    global_load_lds_dwordx4 v8, s[44:45] offset:1024
    s_add_u32 m0, s42, 118336
    s_nop 0
    global_load_lds_dwordx4 v8, s[44:45] offset:2048
    s_add_u32 m0, s42, 118368
    s_nop 0
    global_load_lds_dwordx4 v8, s[44:45] offset:3072
    ds_read_b64_tr_b16 v[224:225], v9 offset:50688
    ds_read_b64_tr_b16 v[228:229], v9 offset:50720
    ds_read_b64_tr_b16 v[232:233], v9 offset:50752
    ds_read_b64_tr_b16 v[236:237], v9 offset:50784
    ds_read_b64_tr_b16 v[240:241], v9 offset:50816
    ds_read_b64_tr_b16 v[244:245], v9 offset:50848
    ds_read_b64_tr_b16 v[248:249], v9 offset:50880
    ds_read_b64_tr_b16 v[252:253], v9 offset:50912
    ds_read_b128 a[0:3], v11 offset:0
    ds_read_b128 a[4:7], v11 offset:64
    ds_read_b128 a[8:11], v11 offset:128
    ds_read_b128 a[12:15], v11 offset:192
    ds_read_b128 a[16:19], v11 offset:256
    ds_read_b128 a[20:23], v11 offset:320
    ds_read_b128 a[24:27], v11 offset:384
    ds_read_b128 a[28:31], v11 offset:448
    ds_read_b128 a[32:35], v11 offset:512
    ds_read_b128 a[36:39], v11 offset:576
    ds_read_b128 a[40:43], v11 offset:640
    ds_read_b128 a[44:47], v11 offset:704
    ds_read_b128 a[48:51], v11 offset:768
    ds_read_b128 a[52:55], v11 offset:832
    ds_read_b128 a[56:59], v11 offset:896
    ds_read_b128 a[60:63], v11 offset:960
    s_waitcnt vmcnt(12)
    s_waitcnt lgkmcnt(0)
    s_barrier
    v_xor_b32 v8, 4194304, v5
    s_add_u32 m0, s42, 0
    s_nop 0
    global_load_lds_dwordx4 v8, s[44:45] offset:0
    s_add_u32 m0, s42, 32
    s_nop 0
    global_load_lds_dwordx4 v8, s[44:45] offset:1024
    s_add_u32 m0, s42, 64
    s_nop 0
    global_load_lds_dwordx4 v8, s[44:45] offset:2048
    s_add_u32 m0, s42, 96
    s_nop 0
    global_load_lds_dwordx4 v8, s[44:45] offset:3072
    ds_read_b64_tr_b16 v[130:131], v10 offset:0
    ds_read_b64_tr_b16 v[134:135], v10 offset:32
    ds_read_b64_tr_b16 v[138:139], v10 offset:64
    ds_read_b64_tr_b16 v[142:143], v10 offset:96
    ds_read_b64_tr_b16 v[146:147], v10 offset:128
    ds_read_b64_tr_b16 v[150:151], v10 offset:160
    ds_read_b64_tr_b16 v[154:155], v10 offset:192
    ds_read_b64_tr_b16 v[158:159], v10 offset:224
    s_waitcnt vmcnt(12)
    s_waitcnt lgkmcnt(0)
    s_barrier
    v_xor_b32 v8, 4718592, v5
    s_add_u32 m0, s42, 16896
    s_nop 0
    global_load_lds_dwordx4 v8, s[44:45] offset:0
    s_add_u32 m0, s42, 16928
    s_nop 0
    global_load_lds_dwordx4 v8, s[44:45] offset:1024
    s_add_u32 m0, s42, 16960
    s_nop 0
    global_load_lds_dwordx4 v8, s[44:45] offset:2048
    s_add_u32 m0, s42, 16992
    s_nop 0
    global_load_lds_dwordx4 v8, s[44:45] offset:3072
    ds_read_b64_tr_b16 v[162:163], v10 offset:16896
    ds_read_b64_tr_b16 v[166:167], v10 offset:16928
    ds_read_b64_tr_b16 v[170:171], v10 offset:16960
    ds_read_b64_tr_b16 v[174:175], v10 offset:16992
    ds_read_b64_tr_b16 v[178:179], v10 offset:17024
    ds_read_b64_tr_b16 v[182:183], v10 offset:17056
    ds_read_b64_tr_b16 v[186:187], v10 offset:17088
    ds_read_b64_tr_b16 v[190:191], v10 offset:17120
    s_waitcnt vmcnt(12)
    s_waitcnt lgkmcnt(0)
    s_barrier
    v_xor_b32 v8, 5242880, v5
    s_add_u32 m0, s42, 33792
    s_nop 0
    global_load_lds_dwordx4 v8, s[44:45] offset:0
    s_add_u32 m0, s42, 33824
    s_nop 0
    global_load_lds_dwordx4 v8, s[44:45] offset:1024
    s_add_u32 m0, s42, 33856
    s_nop 0
    global_load_lds_dwordx4 v8, s[44:45] offset:2048
    s_add_u32 m0, s42, 33888
    s_nop 0
    global_load_lds_dwordx4 v8, s[44:45] offset:3072
    ds_read_b64_tr_b16 v[194:195], v10 offset:33792
    ds_read_b64_tr_b16 v[198:199], v10 offset:33824
    ds_read_b64_tr_b16 v[202:203], v10 offset:33856
    ds_read_b64_tr_b16 v[206:207], v10 offset:33888
    ds_read_b64_tr_b16 v[210:211], v10 offset:33920
    ds_read_b64_tr_b16 v[214:215], v10 offset:33952
    ds_read_b64_tr_b16 v[218:219], v10 offset:33984
    ds_read_b64_tr_b16 v[222:223], v10 offset:34016
    s_waitcnt vmcnt(12)
    s_waitcnt lgkmcnt(0)
    s_barrier
    v_xor_b32 v8, 5767168, v5
    s_add_u32 m0, s42, 50688
    s_nop 0
    global_load_lds_dwordx4 v8, s[44:45] offset:0
    s_add_u32 m0, s42, 50720
    s_nop 0
    global_load_lds_dwordx4 v8, s[44:45] offset:1024
    s_add_u32 m0, s42, 50752
    s_nop 0
    global_load_lds_dwordx4 v8, s[44:45] offset:2048
    s_add_u32 m0, s42, 50784
    s_nop 0
    global_load_lds_dwordx4 v8, s[44:45] offset:3072
    global_store_dwordx4 v16, v[28:31], s[34:35] offset:0 sc1
    global_store_dwordx4 v16, v[28:31], s[34:35] offset:1024 sc1
    global_store_dwordx4 v16, v[28:31], s[34:35] offset:2048 sc1
    global_store_dwordx4 v16, v[28:31], s[34:35] offset:3072 sc1
    s_cmp_eq_u32 s38, 3
    s_cselect_b32 exec_lo, -1, 0
    s_mov_b32 exec_hi, 0
    global_store_dword v17, v28, s[34:35] sc1
    s_mov_b64 exec, -1
    ds_read_b64_tr_b16 v[226:227], v10 offset:50688
    ds_read_b64_tr_b16 v[230:231], v10 offset:50720
    ds_read_b64_tr_b16 v[234:235], v10 offset:50752
    ds_read_b64_tr_b16 v[238:239], v10 offset:50784
    ds_read_b64_tr_b16 v[242:243], v10 offset:50816
    ds_read_b64_tr_b16 v[246:247], v10 offset:50848
    ds_read_b64_tr_b16 v[250:251], v10 offset:50880
    ds_read_b64_tr_b16 v[254:255], v10 offset:50912
    ds_read_b128 a[64:67], v12 offset:0
    ds_read_b128 a[68:71], v12 offset:64
    ds_read_b128 a[72:75], v12 offset:128
    ds_read_b128 a[76:79], v12 offset:192
    ds_read_b128 a[80:83], v12 offset:256
    ds_read_b128 a[84:87], v12 offset:320
    ds_read_b128 a[88:91], v12 offset:384
    ds_read_b128 a[92:95], v12 offset:448
    ds_read_b128 a[96:99], v12 offset:512
    ds_read_b128 a[100:103], v12 offset:576
    ds_read_b128 a[104:107], v12 offset:640
    ds_read_b128 a[108:111], v12 offset:704
    ds_read_b128 a[112:115], v12 offset:768
    ds_read_b128 a[116:119], v12 offset:832
    ds_read_b128 a[120:123], v12 offset:896
    ds_read_b128 a[124:127], v12 offset:960
    s_waitcnt vmcnt(17)
    s_waitcnt lgkmcnt(0)
    s_barrier
    global_load_dword v27, v26, s[34:35] sc1
    v_xor_b32 v8, 6553600, v5
    s_add_u32 m0, s42, 67584
    s_nop 0
    global_load_lds_dwordx4 v8, s[44:45] offset:0
    s_add_u32 m0, s42, 67616
    s_nop 0
    global_load_lds_dwordx4 v8, s[44:45] offset:1024
    s_add_u32 m0, s42, 67648
    s_nop 0
    global_load_lds_dwordx4 v8, s[44:45] offset:2048
    s_add_u32 m0, s42, 67680
    s_nop 0
    global_load_lds_dwordx4 v8, s[44:45] offset:3072
    s_waitcnt vmcnt(18)
    s_waitcnt lgkmcnt(0)
    s_barrier
    v_xor_b32 v8, 7077888, v5
    s_add_u32 m0, s42, 84480
    s_nop 0
    global_load_lds_dwordx4 v8, s[44:45] offset:0
    s_add_u32 m0, s42, 84512
    s_nop 0
    global_load_lds_dwordx4 v8, s[44:45] offset:1024
    s_add_u32 m0, s42, 84544
    s_nop 0
    global_load_lds_dwordx4 v8, s[44:45] offset:2048
    s_add_u32 m0, s42, 84576
    s_nop 0
    global_load_lds_dwordx4 v8, s[44:45] offset:3072
    v_lshlrev_b32 v8, 4, v2
    v_add_u32 v48, 160256, v8
    s_lshl_b32 s49, s38, 2
    v_add_u32 v49, s49, v48
    s_lshl_b32 s49, s38, 10
    s_add_u32 s49, s49, 152064
    v_add_u32 v50, s49, v4
    v_add_u32 v51, 152064, v4
    v_lshl_add_u32 v52, v2, 3, s57
    s_add_u32 s49, s56, s43
    v_lshl_add_u32 v53, v3, 12, s49
    v_lshl_add_u32 v53, v6, 10, v53
    v_lshl_add_u32 v53, v7, 4, v53
    s_waitcnt vmcnt(18)
    s_waitcnt lgkmcnt(0)
    s_barrier
    v_xor_b32 v8, 7602176, v5
    s_add_u32 m0, s42, 101376
    s_nop 0
    global_load_lds_dwordx4 v8, s[44:45] offset:0
    s_add_u32 m0, s42, 101408
    s_nop 0
    global_load_lds_dwordx4 v8, s[44:45] offset:1024
    s_add_u32 m0, s42, 101440
    s_nop 0
    global_load_lds_dwordx4 v8, s[44:45] offset:2048
    s_add_u32 m0, s42, 101472
    s_nop 0
    global_load_lds_dwordx4 v8, s[44:45] offset:3072
    s_waitcnt vmcnt(18)
    s_waitcnt lgkmcnt(0)
    s_barrier
    v_xor_b32 v8, 8126464, v5
    s_add_u32 m0, s42, 118272
    s_nop 0
    global_load_lds_dwordx4 v8, s[44:45] offset:0
    s_add_u32 m0, s42, 118304
    s_nop 0
    global_load_lds_dwordx4 v8, s[44:45] offset:1024
    s_add_u32 m0, s42, 118336
    s_nop 0
    global_load_lds_dwordx4 v8, s[44:45] offset:2048
    s_add_u32 m0, s42, 118368
    s_nop 0
    global_load_lds_dwordx4 v8, s[44:45] offset:3072
    ds_read_b128 a[128:131], v11 offset:0
    ds_read_b128 a[132:135], v11 offset:64
    ds_read_b128 a[136:139], v11 offset:128
    ds_read_b128 a[140:143], v11 offset:192
    ds_read_b128 a[144:147], v11 offset:256
    ds_read_b128 a[148:151], v11 offset:320
    ds_read_b128 a[152:155], v11 offset:384
    ds_read_b128 a[156:159], v11 offset:448
    ds_read_b128 a[160:163], v11 offset:512
    ds_read_b128 a[164:167], v11 offset:576
    ds_read_b128 a[168:171], v11 offset:640
    ds_read_b128 a[172:175], v11 offset:704
    ds_read_b128 a[176:179], v11 offset:768
    ds_read_b128 a[180:183], v11 offset:832
    ds_read_b128 a[184:187], v11 offset:896
    ds_read_b128 a[188:191], v11 offset:960
    s_waitcnt vmcnt(17)
    s_waitcnt vmcnt(12)
    s_waitcnt lgkmcnt(0)
    s_barrier
    v_cmp_ne_u32 vcc, s63, v27
    s_cbranch_vccz FD_51
    s_mov_b32 s69, 65536
FL_50:
    global_load_dword v27, v26, s[34:35] sc1
    s_waitcnt vmcnt(0)
    v_cmp_ne_u32 vcc, s63, v27
    s_cbranch_vccz FD_51
    s_sub_u32 s69, s69, 1
    s_cbranch_scc0 FL_50
FD_51:
    global_load_dwordx4 v[32:35], v14, s[34:35] offset:0 sc1
    global_load_dwordx4 v[64:67], v25, s[34:35] offset:0 sc1
    global_load_dwordx4 v[36:39], v14, s[34:35] offset:1024 sc1
    global_load_dwordx4 v[68:71], v25, s[34:35] offset:1024 sc1
    global_load_dwordx4 v[40:43], v14, s[34:35] offset:2048 sc1
    global_load_dwordx4 v[72:75], v25, s[34:35] offset:2048 sc1
    global_load_dwordx4 v[44:47], v14, s[34:35] offset:3072 sc1
    global_load_dwordx4 v[76:79], v25, s[34:35] offset:3072 sc1
    s_lshl_b32 s68, s2, 7
    s_add_u32 s68, s68, 229376
    v_add_u32 v54, s68, v1
    v_mov_b32 v55, s63
    s_cmp_eq_u32 s38, 0
    s_cselect_b32 exec_lo, -1, 0
    s_mov_b32 exec_hi, 0
    global_store_dword v54, v55, s[34:35] sc1
    s_mov_b64 exec, -1
    s_lshl_b32 s46, s36, 10
    s_lshl_b32 s47, s38, 20
    s_add_u32 s46, s46, s47
    s_lshl2_add_u32 s47, s36, s38
    s_lshl_b32 s47, s47, 17
    s_lshl_b32 s48, s39, 15
    s_add_u32 s46, s46, s48
    s_add_u32 s46, s46, 524288
    v_lshl_add_u32 v4, v3, 13, s46
    v_lshl_add_u32 v4, v2, 6, v4
    s_lshl_b32 s48, s39, 12
    s_add_u32 s47, s47, s48
    s_add_u32 s47, s47, 65536
    v_lshl_add_u32 v6, v0, 6, s47
    global_load_dword v4, v4, s[12:13]
    global_load_dword v6, v6, s[14:15]
    s_cmp_lg_u32 s38, 0
    s_cbranch_scc1 AQ_52
    ds_read_b128 a[192:195], v12 offset:0
    ds_read_b128 a[196:199], v12 offset:64
    ds_read_b128 a[200:203], v12 offset:128
    ds_read_b128 a[204:207], v12 offset:192
    ds_read_b128 a[208:211], v12 offset:256
    ds_read_b128 a[212:215], v12 offset:320
    ds_read_b128 a[216:219], v12 offset:384
    ds_read_b128 a[220:223], v12 offset:448
    ds_read_b128 a[224:227], v12 offset:512
    ds_read_b128 a[228:231], v12 offset:576
    ds_read_b128 a[232:235], v12 offset:640
    ds_read_b128 a[236:239], v12 offset:704
    ds_read_b128 a[240:243], v12 offset:768
    ds_read_b128 a[244:247], v12 offset:832
    ds_read_b128 a[248:251], v12 offset:896
    ds_read_b128 a[252:255], v12 offset:960
AQ_52:
    s_waitcnt vmcnt(19)
    s_waitcnt lgkmcnt(0)
    s_barrier
    s_cmp_lg_u32 s38, 1
    s_cbranch_scc1 AQ_53
    ds_read_b128 a[192:195], v12 offset:0
    ds_read_b128 a[196:199], v12 offset:64
    ds_read_b128 a[200:203], v12 offset:128
    ds_read_b128 a[204:207], v12 offset:192
    ds_read_b128 a[208:211], v12 offset:256
    ds_read_b128 a[212:215], v12 offset:320
    ds_read_b128 a[216:219], v12 offset:384
    ds_read_b128 a[220:223], v12 offset:448
    ds_read_b128 a[224:227], v12 offset:512
    ds_read_b128 a[228:231], v12 offset:576
    ds_read_b128 a[232:235], v12 offset:640
    ds_read_b128 a[236:239], v12 offset:704
    ds_read_b128 a[240:243], v12 offset:768
    ds_read_b128 a[244:247], v12 offset:832
    ds_read_b128 a[248:251], v12 offset:896
    ds_read_b128 a[252:255], v12 offset:960
AQ_53:
    s_waitcnt vmcnt(15)
    s_waitcnt lgkmcnt(0)
    s_barrier
    s_cmp_lg_u32 s38, 2
    s_cbranch_scc1 AQ_54
    ds_read_b128 a[192:195], v12 offset:0
    ds_read_b128 a[196:199], v12 offset:64
    ds_read_b128 a[200:203], v12 offset:128
    ds_read_b128 a[204:207], v12 offset:192
    ds_read_b128 a[208:211], v12 offset:256
    ds_read_b128 a[212:215], v12 offset:320
    ds_read_b128 a[216:219], v12 offset:384
    ds_read_b128 a[220:223], v12 offset:448
    ds_read_b128 a[224:227], v12 offset:512
    ds_read_b128 a[228:231], v12 offset:576
    ds_read_b128 a[232:235], v12 offset:640
    ds_read_b128 a[236:239], v12 offset:704
    ds_read_b128 a[240:243], v12 offset:768
    ds_read_b128 a[244:247], v12 offset:832
    ds_read_b128 a[248:251], v12 offset:896
    ds_read_b128 a[252:255], v12 offset:960
AQ_54:
    s_waitcnt vmcnt(11)
    s_waitcnt lgkmcnt(0)
    s_barrier
    s_cmp_lg_u32 s38, 3
    s_cbranch_scc1 AQ_55
    ds_read_b128 a[192:195], v12 offset:0
    ds_read_b128 a[196:199], v12 offset:64
    ds_read_b128 a[200:203], v12 offset:128
    ds_read_b128 a[204:207], v12 offset:192
    ds_read_b128 a[208:211], v12 offset:256
    ds_read_b128 a[212:215], v12 offset:320
    ds_read_b128 a[216:219], v12 offset:384
    ds_read_b128 a[220:223], v12 offset:448
    ds_read_b128 a[224:227], v12 offset:512
    ds_read_b128 a[228:231], v12 offset:576
    ds_read_b128 a[232:235], v12 offset:640
    ds_read_b128 a[236:239], v12 offset:704
    ds_read_b128 a[240:243], v12 offset:768
    ds_read_b128 a[244:247], v12 offset:832
    ds_read_b128 a[248:251], v12 offset:896
    ds_read_b128 a[252:255], v12 offset:960
AQ_55:
    s_mov_b32 s69, 65536
    s_branch PC_57
PL_56:
    global_load_dwordx4 v[32:35], v14, s[34:35] offset:0 sc1
    global_load_dwordx4 v[64:67], v25, s[34:35] offset:0 sc1
    global_load_dwordx4 v[36:39], v14, s[34:35] offset:1024 sc1
    global_load_dwordx4 v[68:71], v25, s[34:35] offset:1024 sc1
    global_load_dwordx4 v[40:43], v14, s[34:35] offset:2048 sc1
    global_load_dwordx4 v[72:75], v25, s[34:35] offset:2048 sc1
    global_load_dwordx4 v[44:47], v14, s[34:35] offset:3072 sc1
    global_load_dwordx4 v[76:79], v25, s[34:35] offset:3072 sc1
    s_waitcnt vmcnt(0)
PC_57:
    s_waitcnt vmcnt(10)
    v_max_u32 v8, v32, v33
    v_max3_u32 v8, v8, v34, v35
    s_waitcnt vmcnt(8)
    v_max3_u32 v8, v8, v36, v37
    v_max3_u32 v8, v8, v38, v39
    s_waitcnt vmcnt(6)
    v_max3_u32 v8, v8, v40, v41
    v_max3_u32 v8, v8, v42, v43
    s_waitcnt vmcnt(4)
    v_max3_u32 v8, v8, v44, v45
    v_max3_u32 v8, v8, v46, v47
    v_max3_u32 v8, v8, v64, v65
    v_max3_u32 v8, v8, v66, v67
    v_max3_u32 v8, v8, v68, v69
    v_max3_u32 v8, v8, v70, v71
    v_max3_u32 v8, v8, v72, v73
    v_max3_u32 v8, v8, v74, v75
    s_waitcnt vmcnt(3)
    v_max3_u32 v8, v8, v76, v77
    v_max3_u32 v8, v8, v78, v79
    v_cmp_eq_u32 vcc, -1, v8
    s_cbranch_vccz PD_58
    s_sub_u32 s69, s69, 1
    s_cbranch_scc0 PL_56
PD_58:
    s_mul_i32 s46, s36, 7
    s_lshr_b32 s46, s46, 1
    s_lshl_b32 s47, s39, 2
    s_add_u32 s47, s47, s38
    s_lshl_b32 s48, s46, 4
    s_add_u32 s48, s48, s47
    s_lshl_b32 s48, s48, 12
    v_lshl_add_u32 v5, v0, 6, s48
    s_mul_i32 s47, s47, 28672
    s_lshl_b32 s46, s46, 7
    s_add_u32 s46, s46, s47
    v_lshrrev_b32 v14, 3, v0
    v_mul_u32_u24 v14, 3584, v14
    v_lshl_add_u32 v14, v7, 6, v14
    v_add_u32 v14, s46, v14
    global_load_dword v14, v14, s[18:19]
    global_load_dword v5, v5, s[22:23]
    v_lshlrev_b32 v80, 16, v32
    v_and_b32 v81, 0xffff0000, v32
    v_lshlrev_b32 v82, 16, v64
    v_and_b32 v83, 0xffff0000, v64
    v_pk_add_f32 v[80:81], v[80:81], v[82:83]
    v_cvt_pk_bf16_f32 v32, v80, v81
    v_lshlrev_b32 v84, 16, v33
    v_and_b32 v85, 0xffff0000, v33
    v_lshlrev_b32 v86, 16, v65
    v_and_b32 v87, 0xffff0000, v65
    v_pk_add_f32 v[84:85], v[84:85], v[86:87]
    v_cvt_pk_bf16_f32 v33, v84, v85
    v_lshlrev_b32 v88, 16, v34
    v_and_b32 v89, 0xffff0000, v34
    v_lshlrev_b32 v90, 16, v66
    v_and_b32 v91, 0xffff0000, v66
    v_pk_add_f32 v[88:89], v[88:89], v[90:91]
    v_cvt_pk_bf16_f32 v34, v88, v89
    v_lshlrev_b32 v92, 16, v35
    v_and_b32 v93, 0xffff0000, v35
    v_lshlrev_b32 v94, 16, v67
    v_and_b32 v95, 0xffff0000, v67
    v_pk_add_f32 v[92:93], v[92:93], v[94:95]
    v_cvt_pk_bf16_f32 v35, v92, v93
    ds_write_b128 v15, v[32:35] offset:0
    v_lshlrev_b32 v80, 16, v36
    v_and_b32 v81, 0xffff0000, v36
    v_lshlrev_b32 v82, 16, v68
    v_and_b32 v83, 0xffff0000, v68
    v_pk_add_f32 v[80:81], v[80:81], v[82:83]
    v_cvt_pk_bf16_f32 v36, v80, v81
    v_lshlrev_b32 v84, 16, v37
    v_and_b32 v85, 0xffff0000, v37
    v_lshlrev_b32 v86, 16, v69
    v_and_b32 v87, 0xffff0000, v69
    v_pk_add_f32 v[84:85], v[84:85], v[86:87]
    v_cvt_pk_bf16_f32 v37, v84, v85
    v_lshlrev_b32 v88, 16, v38
    v_and_b32 v89, 0xffff0000, v38
    v_lshlrev_b32 v90, 16, v70
    v_and_b32 v91, 0xffff0000, v70
    v_pk_add_f32 v[88:89], v[88:89], v[90:91]
    v_cvt_pk_bf16_f32 v38, v88, v89
    v_lshlrev_b32 v92, 16, v39
    v_and_b32 v93, 0xffff0000, v39
    v_lshlrev_b32 v94, 16, v71
    v_and_b32 v95, 0xffff0000, v71
    v_pk_add_f32 v[92:93], v[92:93], v[94:95]
    v_cvt_pk_bf16_f32 v39, v92, v93
    ds_write_b128 v15, v[36:39] offset:1056
    v_lshlrev_b32 v80, 16, v40
    v_and_b32 v81, 0xffff0000, v40
    v_lshlrev_b32 v82, 16, v72
    v_and_b32 v83, 0xffff0000, v72
    v_pk_add_f32 v[80:81], v[80:81], v[82:83]
    v_cvt_pk_bf16_f32 v40, v80, v81
    v_lshlrev_b32 v84, 16, v41
    v_and_b32 v85, 0xffff0000, v41
    v_lshlrev_b32 v86, 16, v73
    v_and_b32 v87, 0xffff0000, v73
    v_pk_add_f32 v[84:85], v[84:85], v[86:87]
    v_cvt_pk_bf16_f32 v41, v84, v85
    v_lshlrev_b32 v88, 16, v42
    v_and_b32 v89, 0xffff0000, v42
    v_lshlrev_b32 v90, 16, v74
    v_and_b32 v91, 0xffff0000, v74
    v_pk_add_f32 v[88:89], v[88:89], v[90:91]
    v_cvt_pk_bf16_f32 v42, v88, v89
    v_lshlrev_b32 v92, 16, v43
    v_and_b32 v93, 0xffff0000, v43
    v_lshlrev_b32 v94, 16, v75
    v_and_b32 v95, 0xffff0000, v75
    v_pk_add_f32 v[92:93], v[92:93], v[94:95]
    v_cvt_pk_bf16_f32 v43, v92, v93
    ds_write_b128 v15, v[40:43] offset:2112
    v_lshlrev_b32 v80, 16, v44
    v_and_b32 v81, 0xffff0000, v44
    v_lshlrev_b32 v82, 16, v76
    v_and_b32 v83, 0xffff0000, v76
    v_pk_add_f32 v[80:81], v[80:81], v[82:83]
    v_cvt_pk_bf16_f32 v44, v80, v81
    v_lshlrev_b32 v84, 16, v45
    v_and_b32 v85, 0xffff0000, v45
    v_lshlrev_b32 v86, 16, v77
    v_and_b32 v87, 0xffff0000, v77
    v_pk_add_f32 v[84:85], v[84:85], v[86:87]
    v_cvt_pk_bf16_f32 v45, v84, v85
    v_lshlrev_b32 v88, 16, v46
    v_and_b32 v89, 0xffff0000, v46
    v_lshlrev_b32 v90, 16, v78
    v_and_b32 v91, 0xffff0000, v78
    v_pk_add_f32 v[88:89], v[88:89], v[90:91]
    v_cvt_pk_bf16_f32 v46, v88, v89
    v_lshlrev_b32 v92, 16, v47
    v_and_b32 v93, 0xffff0000, v47
    v_lshlrev_b32 v94, 16, v79
    v_and_b32 v95, 0xffff0000, v79
    v_pk_add_f32 v[92:93], v[92:93], v[94:95]
    v_cvt_pk_bf16_f32 v47, v92, v93
    ds_write_b128 v15, v[44:47] offset:3168
    s_waitcnt lgkmcnt(0)
    s_barrier
    ds_read_b128 v[64:67], v13 offset:0
    ds_read_b128 v[68:71], v13 offset:64
    ds_read_b128 v[72:75], v13 offset:128
    ds_read_b128 v[76:79], v13 offset:192
    ds_read_b128 v[80:83], v13 offset:256
    ds_read_b128 v[84:87], v13 offset:320
    ds_read_b128 v[88:91], v13 offset:384
    ds_read_b128 v[92:95], v13 offset:448
    ds_read_b128 v[96:99], v13 offset:512
    ds_read_b128 v[100:103], v13 offset:576
    ds_read_b128 v[104:107], v13 offset:640
    ds_read_b128 v[108:111], v13 offset:704
    ds_read_b128 v[112:115], v13 offset:768
    ds_read_b128 v[116:119], v13 offset:832
    ds_read_b128 v[120:123], v13 offset:896
    ds_read_b128 v[124:127], v13 offset:960
    s_waitcnt lgkmcnt(15)
    v_mfma_f32_16x16x32_bf16 v[16:19], a[0:3], v[64:67], 0
    v_mfma_f32_16x16x32_bf16 v[20:23], a[64:67], v[64:67], 0
    v_mfma_f32_16x16x32_bf16 v[24:27], a[128:131], v[64:67], 0
    s_waitcnt lgkmcnt(14)
    v_mfma_f32_16x16x32_bf16 v[16:19], a[4:7], v[68:71], v[16:19]
    v_mfma_f32_16x16x32_bf16 v[20:23], a[68:71], v[68:71], v[20:23]
    v_mfma_f32_16x16x32_bf16 v[24:27], a[132:135], v[68:71], v[24:27]
    s_waitcnt lgkmcnt(13)
    v_mfma_f32_16x16x32_bf16 v[16:19], a[8:11], v[72:75], v[16:19]
    v_mfma_f32_16x16x32_bf16 v[20:23], a[72:75], v[72:75], v[20:23]
    v_mfma_f32_16x16x32_bf16 v[24:27], a[136:139], v[72:75], v[24:27]
    s_waitcnt lgkmcnt(12)
    v_mfma_f32_16x16x32_bf16 v[16:19], a[12:15], v[76:79], v[16:19]
    v_mfma_f32_16x16x32_bf16 v[20:23], a[76:79], v[76:79], v[20:23]
    v_mfma_f32_16x16x32_bf16 v[24:27], a[140:143], v[76:79], v[24:27]
    s_waitcnt lgkmcnt(0)
    v_mfma_f32_16x16x32_bf16 v[16:19], a[16:19], v[80:83], v[16:19]
    ds_read_b64_tr_b16 a[0:1], v9 offset:0
    ds_read_b64_tr_b16 a[2:3], v10 offset:0
    v_mfma_f32_16x16x32_bf16 v[20:23], a[80:83], v[80:83], v[20:23]
    ds_read_b64_tr_b16 a[64:65], v9 offset:33792
    ds_read_b64_tr_b16 a[66:67], v10 offset:33792
    v_mfma_f32_16x16x32_bf16 v[24:27], a[144:147], v[80:83], v[24:27]
    ds_read_b64_tr_b16 a[4:5], v9 offset:32
    ds_read_b64_tr_b16 a[6:7], v10 offset:32
    v_mfma_f32_16x16x32_bf16 v[16:19], a[20:23], v[84:87], v[16:19]
    ds_read_b64_tr_b16 a[68:69], v9 offset:33824
    ds_read_b64_tr_b16 a[70:71], v10 offset:33824
    v_mfma_f32_16x16x32_bf16 v[20:23], a[84:87], v[84:87], v[20:23]
    ds_read_b64_tr_b16 a[8:9], v9 offset:64
    ds_read_b64_tr_b16 a[10:11], v10 offset:64
    v_mfma_f32_16x16x32_bf16 v[24:27], a[148:151], v[84:87], v[24:27]
    ds_read_b64_tr_b16 a[72:73], v9 offset:33856
    ds_read_b64_tr_b16 a[74:75], v10 offset:33856
    v_mfma_f32_16x16x32_bf16 v[16:19], a[24:27], v[88:91], v[16:19]
    ds_read_b64_tr_b16 a[12:13], v9 offset:96
    ds_read_b64_tr_b16 a[14:15], v10 offset:96
    v_mfma_f32_16x16x32_bf16 v[20:23], a[88:91], v[88:91], v[20:23]
    ds_read_b64_tr_b16 a[76:77], v9 offset:33888
    ds_read_b64_tr_b16 a[78:79], v10 offset:33888
    v_mfma_f32_16x16x32_bf16 v[24:27], a[152:155], v[88:91], v[24:27]
    ds_read_b64_tr_b16 a[16:17], v9 offset:128
    ds_read_b64_tr_b16 a[18:19], v10 offset:128
    v_mfma_f32_16x16x32_bf16 v[16:19], a[28:31], v[92:95], v[16:19]
    ds_read_b64_tr_b16 a[80:81], v9 offset:33920
    ds_read_b64_tr_b16 a[82:83], v10 offset:33920
    v_mfma_f32_16x16x32_bf16 v[20:23], a[92:95], v[92:95], v[20:23]
    ds_read_b64_tr_b16 a[20:21], v9 offset:160
    ds_read_b64_tr_b16 a[22:23], v10 offset:160
    v_mfma_f32_16x16x32_bf16 v[24:27], a[156:159], v[92:95], v[24:27]
    ds_read_b64_tr_b16 a[84:85], v9 offset:33952
    ds_read_b64_tr_b16 a[86:87], v10 offset:33952
    v_mfma_f32_16x16x32_bf16 v[16:19], a[32:35], v[96:99], v[16:19]
    ds_read_b64_tr_b16 a[24:25], v9 offset:192
    ds_read_b64_tr_b16 a[26:27], v10 offset:192
    v_mfma_f32_16x16x32_bf16 v[20:23], a[96:99], v[96:99], v[20:23]
    ds_read_b64_tr_b16 a[88:89], v9 offset:33984
    ds_read_b64_tr_b16 a[90:91], v10 offset:33984
    v_mfma_f32_16x16x32_bf16 v[24:27], a[160:163], v[96:99], v[24:27]
    ds_read_b64_tr_b16 a[28:29], v9 offset:224
    ds_read_b64_tr_b16 a[30:31], v10 offset:224
    v_mfma_f32_16x16x32_bf16 v[16:19], a[36:39], v[100:103], v[16:19]
    ds_read_b64_tr_b16 a[92:93], v9 offset:34016
    ds_read_b64_tr_b16 a[94:95], v10 offset:34016
    v_mfma_f32_16x16x32_bf16 v[20:23], a[100:103], v[100:103], v[20:23]
    ds_read_b64_tr_b16 a[32:33], v9 offset:16896
    ds_read_b64_tr_b16 a[34:35], v10 offset:16896
    v_mfma_f32_16x16x32_bf16 v[24:27], a[164:167], v[100:103], v[24:27]
    ds_read_b64_tr_b16 a[96:97], v9 offset:50688
    ds_read_b64_tr_b16 a[98:99], v10 offset:50688
    v_mfma_f32_16x16x32_bf16 v[16:19], a[40:43], v[104:107], v[16:19]
    ds_read_b64_tr_b16 a[36:37], v9 offset:16928
    ds_read_b64_tr_b16 a[38:39], v10 offset:16928
    v_mfma_f32_16x16x32_bf16 v[20:23], a[104:107], v[104:107], v[20:23]
    ds_read_b64_tr_b16 a[100:101], v9 offset:50720
    ds_read_b64_tr_b16 a[102:103], v10 offset:50720
    v_mfma_f32_16x16x32_bf16 v[24:27], a[168:171], v[104:107], v[24:27]
    ds_read_b64_tr_b16 a[40:41], v9 offset:16960
    ds_read_b64_tr_b16 a[42:43], v10 offset:16960
    v_mfma_f32_16x16x32_bf16 v[16:19], a[44:47], v[108:111], v[16:19]
    ds_read_b64_tr_b16 a[104:105], v9 offset:50752
    ds_read_b64_tr_b16 a[106:107], v10 offset:50752
    v_mfma_f32_16x16x32_bf16 v[20:23], a[108:111], v[108:111], v[20:23]
    ds_read_b64_tr_b16 a[44:45], v9 offset:16992
    ds_read_b64_tr_b16 a[46:47], v10 offset:16992
    v_mfma_f32_16x16x32_bf16 v[24:27], a[172:175], v[108:111], v[24:27]
    ds_read_b64_tr_b16 a[108:109], v9 offset:50784
    ds_read_b64_tr_b16 a[110:111], v10 offset:50784
    v_mfma_f32_16x16x32_bf16 v[16:19], a[48:51], v[112:115], v[16:19]
    ds_read_b64_tr_b16 a[48:49], v9 offset:17024
    ds_read_b64_tr_b16 a[50:51], v10 offset:17024
    v_mfma_f32_16x16x32_bf16 v[20:23], a[112:115], v[112:115], v[20:23]
    ds_read_b64_tr_b16 a[112:113], v9 offset:50816
    ds_read_b64_tr_b16 a[114:115], v10 offset:50816
    v_mfma_f32_16x16x32_bf16 v[24:27], a[176:179], v[112:115], v[24:27]
    v_mfma_f32_16x16x32_bf16 v[16:19], a[52:55], v[116:119], v[16:19]
    ds_read_b64_tr_b16 a[52:53], v9 offset:17056
    ds_read_b64_tr_b16 a[54:55], v10 offset:17056
    v_mfma_f32_16x16x32_bf16 v[20:23], a[116:119], v[116:119], v[20:23]
    ds_read_b64_tr_b16 a[116:117], v9 offset:50848
    ds_read_b64_tr_b16 a[118:119], v10 offset:50848
    v_mfma_f32_16x16x32_bf16 v[24:27], a[180:183], v[116:119], v[24:27]
    v_mfma_f32_16x16x32_bf16 v[16:19], a[56:59], v[120:123], v[16:19]
    ds_read_b64_tr_b16 a[56:57], v9 offset:17088
    ds_read_b64_tr_b16 a[58:59], v10 offset:17088
    v_mfma_f32_16x16x32_bf16 v[20:23], a[120:123], v[120:123], v[20:23]
    ds_read_b64_tr_b16 a[120:121], v9 offset:50880
    ds_read_b64_tr_b16 a[122:123], v10 offset:50880
    v_mfma_f32_16x16x32_bf16 v[24:27], a[184:187], v[120:123], v[24:27]
    v_mfma_f32_16x16x32_bf16 v[16:19], a[60:63], v[124:127], v[16:19]
    ds_read_b64_tr_b16 a[60:61], v9 offset:17120
    ds_read_b64_tr_b16 a[62:63], v10 offset:17120
    v_mfma_f32_16x16x32_bf16 v[20:23], a[124:127], v[124:127], v[20:23]
    ds_read_b64_tr_b16 a[124:125], v9 offset:50912
    ds_read_b64_tr_b16 a[126:127], v10 offset:50912
    v_mfma_f32_16x16x32_bf16 v[24:27], a[188:191], v[124:127], v[24:27]
    v_mfma_f32_16x16x32_bf16 v[28:31], a[192:195], v[64:67], 0
    v_mfma_f32_16x16x32_bf16 v[60:63], a[196:199], v[68:71], 0
    v_mfma_f32_16x16x32_bf16 v[28:31], a[200:203], v[72:75], v[28:31]
    v_mfma_f32_16x16x32_bf16 v[60:63], a[204:207], v[76:79], v[60:63]
    v_mfma_f32_16x16x32_bf16 v[28:31], a[208:211], v[80:83], v[28:31]
    v_mfma_f32_16x16x32_bf16 v[60:63], a[212:215], v[84:87], v[60:63]
    v_mfma_f32_16x16x32_bf16 v[28:31], a[216:219], v[88:91], v[28:31]
    v_mfma_f32_16x16x32_bf16 v[60:63], a[220:223], v[92:95], v[60:63]
    v_mfma_f32_16x16x32_bf16 v[28:31], a[224:227], v[96:99], v[28:31]
    v_mfma_f32_16x16x32_bf16 v[60:63], a[228:231], v[100:103], v[60:63]
    v_mfma_f32_16x16x32_bf16 v[28:31], a[232:235], v[104:107], v[28:31]
    v_mfma_f32_16x16x32_bf16 v[60:63], a[236:239], v[108:111], v[60:63]
    v_mfma_f32_16x16x32_bf16 v[28:31], a[240:243], v[112:115], v[28:31]
    v_mfma_f32_16x16x32_bf16 v[60:63], a[244:247], v[116:119], v[60:63]
    v_mfma_f32_16x16x32_bf16 v[28:31], a[248:251], v[120:123], v[28:31]
    v_mfma_f32_16x16x32_bf16 v[60:63], a[252:255], v[124:127], v[60:63]
    v_max3_f32 v32, v16, v17, v18
    v_max3_f32 v32, v32, v19, v20
    v_max3_f32 v32, v32, v21, v22
    v_max3_f32 v32, v32, v23, v24
    v_max3_f32 v32, v32, v25, v26
    v_max_f32 v32, v32, v27
    s_nop 1
    v_pk_add_f32 v[28:29], v[28:29], v[60:61]
    v_pk_add_f32 v[30:31], v[30:31], v[62:63]
    v_max3_f32 v32, v32, v28, v29
    v_max3_f32 v32, v32, v30, v31
    v_mov_b32 v33, v32
    s_nop 1
    v_permlane16_swap_b32 v32, v33
    v_max_f32 v32, v32, v33
    v_mov_b32 v33, v32
    s_nop 1
    v_permlane32_swap_b32 v32, v33
    v_max_f32 v32, v32, v33
    ds_write_b32 v49, v32
    s_waitcnt lgkmcnt(0)
    s_barrier
    ds_read_b128 v[32:35], v48
    s_waitcnt lgkmcnt(0)
    v_max3_f32 v32, v32, v33, v34
    v_max_f32 v54, v32, v35
    v_pk_add_f32 v[16:17], v[16:17], v[54:55] op_sel_hi:[1,0] neg_lo:[0,1] neg_hi:[0,1]
    v_pk_add_f32 v[18:19], v[18:19], v[54:55] op_sel_hi:[1,0] neg_lo:[0,1] neg_hi:[0,1]
    v_pk_add_f32 v[20:21], v[20:21], v[54:55] op_sel_hi:[1,0] neg_lo:[0,1] neg_hi:[0,1]
    v_pk_add_f32 v[22:23], v[22:23], v[54:55] op_sel_hi:[1,0] neg_lo:[0,1] neg_hi:[0,1]
    v_pk_add_f32 v[24:25], v[24:25], v[54:55] op_sel_hi:[1,0] neg_lo:[0,1] neg_hi:[0,1]
    v_pk_add_f32 v[26:27], v[26:27], v[54:55] op_sel_hi:[1,0] neg_lo:[0,1] neg_hi:[0,1]
    v_pk_add_f32 v[28:29], v[28:29], v[54:55] op_sel_hi:[1,0] neg_lo:[0,1] neg_hi:[0,1]
    v_pk_add_f32 v[30:31], v[30:31], v[54:55] op_sel_hi:[1,0] neg_lo:[0,1] neg_hi:[0,1]
    v_exp_f32 v16, v16
    v_exp_f32 v17, v17
    v_exp_f32 v18, v18
    v_exp_f32 v19, v19
    v_cvt_pk_bf16_f32 v36, v16, v17
    v_exp_f32 v20, v20
    v_exp_f32 v21, v21
    v_cvt_pk_bf16_f32 v37, v18, v19
    v_exp_f32 v22, v22
    v_exp_f32 v23, v23
    v_cvt_pk_bf16_f32 v38, v20, v21
    v_exp_f32 v24, v24
    v_exp_f32 v25, v25
    v_cvt_pk_bf16_f32 v39, v22, v23
    ds_write_b128 v50, v[36:39]
    v_exp_f32 v26, v26
    v_exp_f32 v27, v27
    v_cvt_pk_bf16_f32 v40, v24, v25
    v_exp_f32 v28, v28
    v_exp_f32 v29, v29
    v_cvt_pk_bf16_f32 v41, v26, v27
    v_exp_f32 v30, v30
    v_exp_f32 v31, v31
    v_cvt_pk_bf16_f32 v42, v28, v29
    v_cvt_pk_bf16_f32 v43, v30, v31
    ds_write_b128 v50, v[40:43] offset:4096
    v_pk_add_f32 v[16:17], v[16:17], v[24:25]
    v_pk_add_f32 v[18:19], v[18:19], v[26:27]
    v_pk_add_f32 v[20:21], v[20:21], v[28:29]
    v_pk_add_f32 v[22:23], v[22:23], v[30:31]
    v_pk_add_f32 v[16:17], v[16:17], v[20:21]
    v_pk_add_f32 v[18:19], v[18:19], v[22:23]
    v_pk_add_f32 v[16:17], v[16:17], v[18:19]
    v_add_f32 v16, v16, v17
    v_mov_b32 v17, v16
    s_nop 1
    v_permlane16_swap_b32 v16, v17
    v_add_f32 v16, v16, v17
    v_mov_b32 v17, v16
    s_nop 1
    v_permlane32_swap_b32 v16, v17
    v_add_f32 v16, v16, v17
    ds_write_b32 v49, v16 offset:256
    s_waitcnt lgkmcnt(0)
    s_barrier
    ds_read_b128 v[64:67], v51 offset:0
    ds_read_b128 v[68:71], v51 offset:1024
    ds_read_b128 v[72:75], v51 offset:2048
    ds_read_b128 v[76:79], v51 offset:3072
    ds_read_b128 v[80:83], v51 offset:4096
    ds_read_b128 v[84:87], v51 offset:5120
    ds_read_b128 v[88:91], v51 offset:6144
    ds_read_b128 v[92:95], v51 offset:7168
    s_cmp_lg_u32 s38, 3
    s_cbranch_scc1 AS_59
    ds_read_b128 v[32:35], v48 offset:256
    s_waitcnt lgkmcnt(0)
    v_add_f32 v32, v32, v33
    v_add_f32 v34, v34, v35
    v_add_f32 v55, v32, v34
    s_mov_b64 exec, 0xffff
    global_store_dwordx2 v52, v[54:55], s[34:35] sc1
    s_mov_b64 exec, -1
AS_59:
    s_waitcnt lgkmcnt(7)
    v_mfma_f32_16x16x32_bf16 v[96:99], v[64:67], v[128:131], 0
    v_mfma_f32_16x16x32_bf16 v[100:103], v[64:67], v[132:135], 0
    v_mfma_f32_16x16x32_bf16 v[104:107], v[64:67], v[136:139], 0
    v_mfma_f32_16x16x32_bf16 v[108:111], v[64:67], v[140:143], 0
    s_waitcnt lgkmcnt(6)
    v_mfma_f32_16x16x32_bf16 v[96:99], v[68:71], v[160:163], v[96:99]
    v_mfma_f32_16x16x32_bf16 v[100:103], v[68:71], v[164:167], v[100:103]
    v_mfma_f32_16x16x32_bf16 v[104:107], v[68:71], v[168:171], v[104:107]
    v_mfma_f32_16x16x32_bf16 v[108:111], v[68:71], v[172:175], v[108:111]
    s_waitcnt lgkmcnt(5)
    v_mfma_f32_16x16x32_bf16 v[96:99], v[72:75], v[192:195], v[96:99]
    v_mfma_f32_16x16x32_bf16 v[100:103], v[72:75], v[196:199], v[100:103]
    v_mfma_f32_16x16x32_bf16 v[104:107], v[72:75], v[200:203], v[104:107]
    v_mfma_f32_16x16x32_bf16 v[108:111], v[72:75], v[204:207], v[108:111]
    s_waitcnt lgkmcnt(4)
    v_mfma_f32_16x16x32_bf16 v[96:99], v[76:79], v[224:227], v[96:99]
    v_mfma_f32_16x16x32_bf16 v[100:103], v[76:79], v[228:231], v[100:103]
    v_mfma_f32_16x16x32_bf16 v[104:107], v[76:79], v[232:235], v[104:107]
    v_mfma_f32_16x16x32_bf16 v[108:111], v[76:79], v[236:239], v[108:111]
    s_waitcnt lgkmcnt(3)
    v_mfma_f32_16x16x32_bf16 v[96:99], v[80:83], a[0:3], v[96:99]
    v_mfma_f32_16x16x32_bf16 v[100:103], v[80:83], a[4:7], v[100:103]
    v_mfma_f32_16x16x32_bf16 v[104:107], v[80:83], a[8:11], v[104:107]
    v_mfma_f32_16x16x32_bf16 v[108:111], v[80:83], a[12:15], v[108:111]
    s_waitcnt lgkmcnt(2)
    v_mfma_f32_16x16x32_bf16 v[96:99], v[84:87], a[32:35], v[96:99]
    v_mfma_f32_16x16x32_bf16 v[100:103], v[84:87], a[36:39], v[100:103]
    v_mfma_f32_16x16x32_bf16 v[104:107], v[84:87], a[40:43], v[104:107]
    v_mfma_f32_16x16x32_bf16 v[108:111], v[84:87], a[44:47], v[108:111]
    s_waitcnt lgkmcnt(1)
    v_mfma_f32_16x16x32_bf16 v[96:99], v[88:91], a[64:67], v[96:99]
    v_mfma_f32_16x16x32_bf16 v[100:103], v[88:91], a[68:71], v[100:103]
    v_mfma_f32_16x16x32_bf16 v[104:107], v[88:91], a[72:75], v[104:107]
    v_mfma_f32_16x16x32_bf16 v[108:111], v[88:91], a[76:79], v[108:111]
    s_waitcnt lgkmcnt(0)
    v_mfma_f32_16x16x32_bf16 v[96:99], v[92:95], a[96:99], v[96:99]
    v_mfma_f32_16x16x32_bf16 v[100:103], v[92:95], a[100:103], v[100:103]
    v_mfma_f32_16x16x32_bf16 v[104:107], v[92:95], a[104:107], v[104:107]
    v_mfma_f32_16x16x32_bf16 v[108:111], v[92:95], a[108:111], v[108:111]
    v_mfma_f32_16x16x32_bf16 v[112:115], v[64:67], v[144:147], 0
    v_mfma_f32_16x16x32_bf16 v[116:119], v[64:67], v[148:151], 0
    v_mfma_f32_16x16x32_bf16 v[120:123], v[64:67], v[152:155], 0
    s_nop 2
    v_cvt_pk_bf16_f32 v16, v96, v100
    v_cvt_pk_bf16_f32 v18, v97, v101
    v_cvt_pk_bf16_f32 v56, v96, v100
    v_mfma_f32_16x16x32_bf16 v[124:127], v[64:67], v[156:159], 0
    v_cvt_pk_bf16_f32 v17, v104, v108
    v_cvt_pk_bf16_f32 v19, v105, v109
    v_cvt_pk_bf16_f32 v57, v104, v108
    v_mfma_f32_16x16x32_bf16 v[112:115], v[68:71], v[176:179], v[112:115]
    v_mov_b32_dpp v16, v18 row_ror:8 row_mask:0xf bank_mask:0xc
    v_mov_b32_dpp v17, v19 row_ror:8 row_mask:0xf bank_mask:0xc
    v_mov_b32_dpp v18, v56 row_ror:8 row_mask:0xf bank_mask:0x3
    v_mfma_f32_16x16x32_bf16 v[116:119], v[68:71], v[180:183], v[116:119]
    v_mov_b32_dpp v19, v57 row_ror:8 row_mask:0xf bank_mask:0x3
    global_store_dwordx4 v53, v[16:19], s[34:35] offset:0 sc1
    v_cvt_pk_bf16_f32 v24, v98, v102
    v_mfma_f32_16x16x32_bf16 v[120:123], v[68:71], v[184:187], v[120:123]
    v_cvt_pk_bf16_f32 v26, v99, v103
    v_cvt_pk_bf16_f32 v58, v98, v102
    v_cvt_pk_bf16_f32 v25, v106, v110
    v_mfma_f32_16x16x32_bf16 v[124:127], v[68:71], v[188:191], v[124:127]
    v_cvt_pk_bf16_f32 v27, v107, v111
    v_cvt_pk_bf16_f32 v59, v106, v110
    v_mov_b32_dpp v24, v26 row_ror:8 row_mask:0xf bank_mask:0xc
    v_mfma_f32_16x16x32_bf16 v[112:115], v[72:75], v[208:211], v[112:115]
    v_mov_b32_dpp v25, v27 row_ror:8 row_mask:0xf bank_mask:0xc
    v_mov_b32_dpp v26, v58 row_ror:8 row_mask:0xf bank_mask:0x3
    v_mov_b32_dpp v27, v59 row_ror:8 row_mask:0xf bank_mask:0x3
    v_mfma_f32_16x16x32_bf16 v[116:119], v[72:75], v[212:215], v[116:119]
    global_store_dwordx4 v53, v[24:27], s[34:35] offset:2048 sc1
    v_mfma_f32_16x16x32_bf16 v[120:123], v[72:75], v[216:219], v[120:123]
    v_mfma_f32_16x16x32_bf16 v[124:127], v[72:75], v[220:223], v[124:127]
    v_mfma_f32_16x16x32_bf16 v[112:115], v[76:79], v[240:243], v[112:115]
    v_mfma_f32_16x16x32_bf16 v[116:119], v[76:79], v[244:247], v[116:119]
    v_mfma_f32_16x16x32_bf16 v[120:123], v[76:79], v[248:251], v[120:123]
    v_mfma_f32_16x16x32_bf16 v[124:127], v[76:79], v[252:255], v[124:127]
    v_mfma_f32_16x16x32_bf16 v[112:115], v[80:83], a[16:19], v[112:115]
    v_mfma_f32_16x16x32_bf16 v[116:119], v[80:83], a[20:23], v[116:119]
    v_mfma_f32_16x16x32_bf16 v[120:123], v[80:83], a[24:27], v[120:123]
    v_mfma_f32_16x16x32_bf16 v[124:127], v[80:83], a[28:31], v[124:127]
    v_mfma_f32_16x16x32_bf16 v[112:115], v[84:87], a[48:51], v[112:115]
    v_mfma_f32_16x16x32_bf16 v[116:119], v[84:87], a[52:55], v[116:119]
    v_mfma_f32_16x16x32_bf16 v[120:123], v[84:87], a[56:59], v[120:123]
    v_mfma_f32_16x16x32_bf16 v[124:127], v[84:87], a[60:63], v[124:127]
    v_mfma_f32_16x16x32_bf16 v[112:115], v[88:91], a[80:83], v[112:115]
    v_mfma_f32_16x16x32_bf16 v[116:119], v[88:91], a[84:87], v[116:119]
    v_mfma_f32_16x16x32_bf16 v[120:123], v[88:91], a[88:91], v[120:123]
    v_mfma_f32_16x16x32_bf16 v[124:127], v[88:91], a[92:95], v[124:127]
    v_mfma_f32_16x16x32_bf16 v[112:115], v[92:95], a[112:115], v[112:115]
    v_mfma_f32_16x16x32_bf16 v[116:119], v[92:95], a[116:119], v[116:119]
    v_mfma_f32_16x16x32_bf16 v[120:123], v[92:95], a[120:123], v[120:123]
    v_mfma_f32_16x16x32_bf16 v[124:127], v[92:95], a[124:127], v[124:127]
    s_nop 5
    v_cvt_pk_bf16_f32 v32, v112, v116
    v_cvt_pk_bf16_f32 v34, v113, v117
    v_cvt_pk_bf16_f32 v56, v112, v116
    v_cvt_pk_bf16_f32 v33, v120, v124
    v_cvt_pk_bf16_f32 v35, v121, v125
    v_cvt_pk_bf16_f32 v57, v120, v124
    v_mov_b32_dpp v32, v34 row_ror:8 row_mask:0xf bank_mask:0xc
    v_mov_b32_dpp v33, v35 row_ror:8 row_mask:0xf bank_mask:0xc
    v_mov_b32_dpp v34, v56 row_ror:8 row_mask:0xf bank_mask:0x3
    v_mov_b32_dpp v35, v57 row_ror:8 row_mask:0xf bank_mask:0x3
    global_store_dwordx4 v53, v[32:35], s[34:35] offset:128 sc1
    v_cvt_pk_bf16_f32 v40, v114, v118
    v_cvt_pk_bf16_f32 v42, v115, v119
    v_cvt_pk_bf16_f32 v58, v114, v118
    v_cvt_pk_bf16_f32 v41, v122, v126
    v_cvt_pk_bf16_f32 v43, v123, v127
    v_cvt_pk_bf16_f32 v59, v122, v126
    v_mov_b32_dpp v40, v42 row_ror:8 row_mask:0xf bank_mask:0xc
    v_mov_b32_dpp v41, v43 row_ror:8 row_mask:0xf bank_mask:0xc
    v_mov_b32_dpp v42, v58 row_ror:8 row_mask:0xf bank_mask:0x3
    v_mov_b32_dpp v43, v59 row_ror:8 row_mask:0xf bank_mask:0x3
    global_store_dwordx4 v53, v[40:43], s[34:35] offset:2176 sc1
FIN:
END:
    s_endpgm
CODE_END:
.section .rodata,"a"
.p2align 6
.amdhsa_kernel adaLN_cond__compressed_kv_cla__mixer_channel_mlp__decode_kernel
  .amdhsa_next_free_vgpr 512
  .amdhsa_next_free_sgpr 102
  .amdhsa_accum_offset 256
  .amdhsa_group_segment_fixed_size 0
  .amdhsa_kernarg_size 128
  .amdhsa_user_sgpr_count 2
  .amdhsa_user_sgpr_kernarg_segment_ptr 1
  .amdhsa_system_sgpr_workgroup_id_x 1
.end_amdhsa_kernel
```
